```python
import torch

def _softmax(x, axis=-1):
    return torch.softmax(x, dim=axis)
def _gelu(x):
    return torch.nn.functional.gelu(x, approximate="tanh")
def _silu(x):
    return torch.nn.functional.silu(x)
def _sigmoid(x):
    return torch.sigmoid(x)
def _layernorm(x, axis=-1, eps=1e-5):
    m = x.mean(dim=axis, keepdim=True)
    v = x.var(dim=axis, keepdim=True, unbiased=False)
    return (x - m) / torch.sqrt(v + eps)
def _scatter_add(tgt, idx, src, axis=0):
    return tgt.clone().index_add_(axis, idx, src)
def _segment_sum(src, seg, n):
    out = torch.zeros((n,) + src.shape[1:], dtype=src.dtype)
    return out.index_add_(0, seg, src)
def _pad(x, pw):
    flat = tuple(v for pair in reversed(pw) for v in pair)
    return torch.nn.functional.pad(x, flat)

kernel_name = 'interleave_layers__ssm_conv_h3__glu_gated_geglu__prompt'

def setup_inputs():

    _w = (lambda a: (lambda t: t.to(torch.bfloat16) if t.is_floating_point() else t)(torch.as_tensor(a)))
    def _A_setup():
        B, S, D = 1, 2048, 512
        ks = 4
        return {
            "q": _w((lambda *s: torch.randn(*s, dtype=torch.bfloat16) * 0.05)(B, S, D)),
            "k": _w((lambda *s: torch.randn(*s, dtype=torch.bfloat16) * 0.2)(B, S, D)),
            "v": _w((lambda *s: torch.randn(*s, dtype=torch.bfloat16) * 0.2)(B, S, D)),
            "shift_k": _w((lambda *s: torch.randn(*s, dtype=torch.bfloat16) * 0.2)(D, ks) * 0.5),
            "ssm_k": _w((lambda *s: torch.randn(*s, dtype=torch.bfloat16) * 0.4)(D, S) * (1.0 / S ** 0.5)),
            "ssm_D": _w((lambda *s: torch.randn(*s, dtype=torch.bfloat16) * 0.2)(D)),
        }
    _A_in = _A_setup()

    def _B_setup():
        B, S, Dm, Df = 1, 2048, 512, 1792
        return {
            "x": _w((lambda *s: torch.randn(*s, dtype=torch.bfloat16) * 0.05)(B, S, Dm)),
            "w_gate": _w((lambda *s: torch.randn(*s, dtype=torch.bfloat16) * 0.4)(Dm, Df) * (Dm ** -0.5)),
            "w_up": _w((lambda *s: torch.randn(*s, dtype=torch.bfloat16) * 0.4)(Dm, Df) * (Dm ** -0.5)),
            "w_down": _w((lambda *s: torch.randn(*s, dtype=torch.bfloat16) * 0.4)(Df, Dm) * (Df ** -0.5)),
        }
    _B_in = _B_setup()

    return {
        "A_q": _A_in["q"],
        "A_k": _A_in["k"],
        "A_v": _A_in["v"],
        "A_shift_k": _A_in["shift_k"],
        "A_ssm_k": _A_in["ssm_k"],
        "A_ssm_D": _A_in["ssm_D"],
        "B_x": _B_in["x"],
        "B_w_gate": _B_in["w_gate"],
        "B_w_up": _B_in["w_up"],
        "B_w_down": _B_in["w_down"],
    }

def reference(A_q, A_k, A_v, A_shift_k, A_ssm_k, A_ssm_D, B_x, B_w_gate, B_w_up, B_w_down):
    def _A_ref(q, k, v, shift_k, ssm_k, ssm_D):
        B, S, D = q.shape
        ks = shift_k.shape[-1]
        k_pad = _pad(k, ((0, 0), (ks - 1, 0), (0, 0)))
        k_shift = torch.zeros_like(k)
        for t in range(ks):
            k_shift = k_shift + k_pad[:, t:t + S, :] * shift_k[:, ks - 1 - t][None, None, :]
        kv = k_shift * v
        L = 2 * S
        kv_pad = _pad(kv, ((0, 0), (0, S), (0, 0)))
        kf_pad = _pad(ssm_k, ((0, 0), (0, S)))
        kv_f = (lambda x, axes=(-2,-1): torch.fft.rfft2(x.float(), dim=axes))(kv_pad[:, None, :, :], axes=(1, 2))
        kf_f = (lambda x, axes=(-2,-1): torch.fft.rfft2(x.float(), dim=axes))(kf_pad[:, None, :], axes=(1, 2))
        kf_f = (lambda x, *d: x.permute(*d))(kf_f, 1, 2, 0)
        y_f = kv_f * kf_f[None, :, :, :]
        y = (lambda x, s, axes=(-2,-1): torch.fft.irfft2(x, s=s, dim=axes).to(torch.bfloat16))(y_f, (1, L), axes=(1, 2))[:, 0, :S, :]
        y = y + kv * ssm_D[None, None, :]
        return q * y

    def _B_ref(x, w_gate, w_up, w_down):
        g = torch.einsum("bsd,df->bsf", x, w_gate)
        u = torch.einsum("bsd,df->bsf", x, w_up)
        h = _gelu(g) * u
        return torch.einsum("bsf,fd->bsd", h, w_down)

    x = A_q
    x = x + _A_ref(_layernorm(x, axis=-1), A_k, A_v, A_shift_k, A_ssm_k, A_ssm_D)
    x = x + _B_ref(_layernorm(x, axis=-1), B_w_gate, B_w_up, B_w_down)
    x = x + _A_ref(_layernorm(x, axis=-1), A_k, A_v, A_shift_k, A_ssm_k, A_ssm_D)
    x = x + _B_ref(_layernorm(x, axis=-1), B_w_gate, B_w_up, B_w_down)
    return x
```

```asm
; @launch grid=(256,1,1) block=(256,1,1) lds=163840
.amdgcn_target "amdgcn-amd-amdhsa--gfx950"
.text
.globl interleave_layers__ssm_conv_h3__glu_gated_geglu__prompt_kernel
.p2align 8
.type interleave_layers__ssm_conv_h3__glu_gated_geglu__prompt_kernel,@function
interleave_layers__ssm_conv_h3__glu_gated_geglu__prompt_kernel:
    s_cmp_ge_u32 s2, 256
    s_cbranch_scc1 mega_done
    s_load_dwordx2 s[36:37], s[0:1], 8
    s_load_dwordx2 s[40:41], s[0:1], 16
    s_load_dwordx2 s[44:45], s[0:1], 24
    s_load_dwordx16 s[4:19], s[0:1], 0
    s_load_dwordx8 s[20:27], s[0:1], 64
    s_load_dwordx2 s[28:29], s[0:1], 96
    s_mov_b32 s38, 0x200000
    s_mov_b32 s39, 0x20000
    s_mov_b32 s42, 0x200000
    s_mov_b32 s43, 0x20000
    s_mov_b32 s46, 0x1000
    s_mov_b32 s47, 0x20000

    s_lshr_b32 s80, s2, 3
    s_and_b32 s81, s2, 7
    v_and_b32 v16, 7, v0
    v_lshrrev_b32 v17, 3, v0
    v_lshlrev_b32 v18, 4, v16
    s_lshl_b32 s32, s81, 7
    v_add_u32 v18, s32, v18
    v_lshlrev_b32 v19, 1, v17
    s_lshl_b32 s34, s80, 6
    v_add_u32 v19, s34, v19
    v_lshlrev_b32 v20, 10, v19
    v_add_u32 v20, v20, v18
    v_add_u32 v21, 0xfffff400, v20
    v_add_u32 v22, 0xfffff800, v20
    v_add_u32 v23, 0xfffffc00, v20
    v_lshlrev_b32 v24, 6, v16
    s_lshl_b32 s34, s81, 9
    v_add_u32 v24, s34, v24
    v_mul_u32_u24 v25, 1056, v16
    v_sub_u32 v26, 31, v17
    v_lshlrev_b32 v26, 2, v26
    v_add_u32 v25, v25, v26
    v_readfirstlane_b32 s33, v0
    s_nop 0
    s_lshr_b32 s33, s33, 6
    s_getreg_b32 s62, hwreg(HW_REG_XCC_ID, 0, 4)
    s_and_b32 s62, s62, 7
    v_and_b32 v1, 63, v0
    v_lshlrev_b32 v2, 4, v1
    v_and_b32 v5, 15, v1
    v_lshlrev_b32 v5, 2, v5
    s_mov_b32 s71, 0
    s_waitcnt lgkmcnt(0)
    buffer_load_dwordx4 v[32:35], v21, s[36:39], 0 offen
    buffer_load_dwordx4 v[36:39], v22, s[36:39], 0 offen
    buffer_load_dwordx4 v[40:43], v23, s[36:39], 0 offen
    buffer_load_dwordx4 v[44:47], v20, s[36:39], 0 offen
    buffer_load_dwordx4 v[48:51], v20, s[36:39], 0 offen offset:1024
    buffer_load_dwordx4 v[52:55], v20, s[40:43], 0 offen
    buffer_load_dwordx4 v[56:59], v20, s[40:43], 0 offen offset:1024
    buffer_load_dwordx4 v[60:63], v24, s[44:47], 0 offen
    buffer_load_dwordx4 v[64:67], v24, s[44:47], 0 offen offset:16
    buffer_load_dwordx4 v[68:71], v24, s[44:47], 0 offen offset:32
    buffer_load_dwordx4 v[72:75], v24, s[44:47], 0 offen offset:48
    s_mov_b32 s76, s26
    s_mov_b32 s77, s27
    s_mov_b32 s78, 256
    s_mov_b32 s79, 0x20000
    s_add_u32 s72, s28, 0x3001000
    s_addc_u32 s73, s29, 0
    s_mov_b32 s74, 3072
    s_mov_b32 s75, 0x20000
    s_cmp_lg_u32 s33, 0
    s_cbranch_scc1 mg_nt
    s_lshl_b32 s35, s62, 5
    v_mov_b32 v6, 1
    v_mov_b32 v7, 0
    s_mov_b64 exec, 1
    buffer_atomic_add v6, v7, s[76:79], s35 offen sc0
    s_mov_b64 exec, -1
mg_nt:
    s_cmp_lg_u32 s33, 3
    s_cbranch_scc1 w2e_skip
    s_mov_b32 s44, s22
    s_mov_b32 s45, s23
    s_mov_b32 s46, 0x1c0000
    s_mov_b32 s47, 0x20000
    s_lshr_b32 s34, s2, 4
    s_lshl_b32 s34, s34, 6
    s_and_b32 s35, s2, 15
    s_mul_i32 s35, s35, 114688
    s_add_u32 s52, s34, s35
    v_lshrrev_b32 v26, 2, v1
    v_lshlrev_b32 v26, 10, v26
    v_and_b32 v27, 3, v1
    v_lshlrev_b32 v27, 4, v27
    v_add_u32 v26, v26, v27
    s_mov_b32 m0, 32768
    s_nop 0
    buffer_load_dwordx4 v26, s[44:47], s52 offen lds
    s_add_u32 s52, s52, 16384
    s_mov_b32 m0, 33792
    s_nop 0
    buffer_load_dwordx4 v26, s[44:47], s52 offen lds
    s_add_u32 s52, s52, 16384
    s_mov_b32 m0, 34816
    s_nop 0
    buffer_load_dwordx4 v26, s[44:47], s52 offen lds
    s_add_u32 s52, s52, 16384
    s_mov_b32 m0, 35840
    s_nop 0
    buffer_load_dwordx4 v26, s[44:47], s52 offen lds
    s_add_u32 s52, s52, 16384
    s_mov_b32 m0, 36864
    s_nop 0
    buffer_load_dwordx4 v26, s[44:47], s52 offen lds
    s_add_u32 s52, s52, 16384
    s_mov_b32 m0, 37888
    s_nop 0
    buffer_load_dwordx4 v26, s[44:47], s52 offen lds
    s_add_u32 s52, s52, 16384
    s_mov_b32 m0, 38912
    s_nop 0
    buffer_load_dwordx4 v26, s[44:47], s52 offen lds
w2e_skip:
    s_cmp_lg_u32 s33, 3
    s_cbranch_scc1 cpf_skip
    s_getpc_b64 s[34:35]
pc_1:
    s_add_u32 s34, s34, (interleave_layers__ssm_conv_h3__glu_gated_geglu__prompt_kernel-pc_1)&0xffffffff
    s_addc_u32 s35, s35, ((interleave_layers__ssm_conv_h3__glu_gated_geglu__prompt_kernel-pc_1)>>32)&0xffffffff
    s_lshr_b32 s32, s2, 3
    s_mul_i32 s32, s32, ((mega_end-interleave_layers__ssm_conv_h3__glu_gated_geglu__prompt_kernel+4095)/4096)
    v_add_u32 v76, s32, v1
    v_lshlrev_b32 v76, 7, v76
    v_min_u32 v76, (mega_end-interleave_layers__ssm_conv_h3__glu_gated_geglu__prompt_kernel-4), v76
    v_and_b32 v76, 0xfffffffc, v76
    v_mov_b32 v77, s35
    v_add_co_u32 v76, vcc, s34, v76
    s_nop 1
    v_addc_co_u32 v77, vcc, 0, v77, vcc
    v_cmp_gt_u32 vcc, ((mega_end-interleave_layers__ssm_conv_h3__glu_gated_geglu__prompt_kernel+4095)/4096), v1
    s_nop 0
    s_and_saveexec_b64 s[34:35], vcc
    global_load_dword v3, v[76:77], off
    s_mov_b64 exec, s[34:35]
cpf_skip:
    s_cmp_lg_u32 s33, 2
    s_cbranch_scc1 tlb_skip
    s_mov_b32 s48, s28
    s_mov_b32 s49, s29
    s_mov_b32 s50, 0x3200000
    s_mov_b32 s51, 0x20000
    v_mov_b32 v76, 0
    s_mov_b32 s34, 0x0
    v_writelane_b32 v76, s34, 0
    s_mov_b32 s34, 0x300000
    v_writelane_b32 v76, s34, 1
    s_mov_b32 s34, 0x400000
    v_writelane_b32 v76, s34, 2
    s_mov_b32 s34, 0x700000
    v_writelane_b32 v76, s34, 3
    s_mov_b32 s34, 0xdd0000
    v_writelane_b32 v76, s34, 4
    s_mov_b32 s34, 0x1000000
    v_writelane_b32 v76, s34, 5
    s_mov_b32 s34, 0x1a00000
    v_writelane_b32 v76, s34, 6
    s_mov_b32 s34, 0x2000000
    v_writelane_b32 v76, s34, 7
    s_mov_b32 s34, 0x2200000
    v_writelane_b32 v76, s34, 8
    s_mov_b32 s34, 0x2400000
    v_writelane_b32 v76, s34, 9
    s_mov_b32 s34, 0x2600000
    v_writelane_b32 v76, s34, 10
    s_lshl_b32 s34, s2, 7
    s_mov_b64 exec, 0x7ff
    buffer_load_dword v3, v76, s[48:51], s34 offen
    s_mov_b64 exec, -1
    v_min_u32 v76, 55, v1
    v_lshlrev_b32 v76, 7, v76
    s_mov_b32 s34, 0x3000000

    buffer_load_dword v3, v76, s[48:51], s34 offen sc1
    s_mov_b32 s48, s24
    s_mov_b32 s49, s25
    s_mov_b32 s50, 2097152
    s_lshl_b32 s34, s2, 13
    v_mov_b32 v76, 0
    buffer_load_dword v3, v76, s[48:51], s34 offen
tlb_skip:
    s_cmp_lg_u32 s33, 0
    s_cbranch_scc1 mg_t1
    s_waitcnt vmcnt(0)
    v_mov_b32 v7, 143360
    s_mov_b64 exec, 1
    ds_write_b32 v7, v6
    s_mov_b64 exec, -1
    v_readfirstlane_b32 s63, v6
    s_nop 0
    s_cmp_ge_u32 s63, 32
    s_cbranch_scc1 mg_t1
    s_lshl_b32 s30, s62, 1
    s_lshr_b32 s31, s63, 4
    s_add_u32 s30, s30, s31
    s_and_b32 s31, s63, 15
    s_lshl_b32 s34, s30, 7
    s_add_u32 s34, s34, 0x3000000
    s_add_u32 s64, s28, s34
    s_addc_u32 s65, s29, 0
    s_mov_b32 s66, 128
    s_mov_b32 s67, 0x20000
    v_mov_b32 v6, 0
    v_mov_b32 v7, 0
    s_lshl_b32 s34, s62, 7
    s_lshl_b32 s35, s63, 2
    s_add_u32 s34, s34, s35
    s_lshl_b32 s35, s31, 2
    s_mov_b64 exec, 1
    buffer_store_dword v6, v7, s[72:75], s34 offen
    buffer_store_dword v6, v7, s[72:75], s34 offen offset:2048
    buffer_store_dword v6, v7, s[64:67], s35 offen
    s_mov_b64 exec, -1
    s_cmp_lg_u32 s63, 0
    s_cbranch_scc1 mg_ez
    v_and_b32 v8, 7, v1
    v_lshlrev_b32 v8, 7, v8
    s_lshl_b32 s35, s62, 2
    s_add_u32 s35, s35, 1024
    s_mov_b64 exec, 0xff
    buffer_store_dword v6, v8, s[72:75], s35 offen sc1
    s_mov_b64 exec, -1
mg_ez:
    s_branch mg_t4

mg_t1:
    s_cmp_eq_u32 s33, 3
    s_cbranch_scc1 mg_t3
    s_cmp_eq_u32 s33, 0
    s_cbranch_scc1 mg_t0
    s_cmp_eq_u32 s33, 2
    s_cbranch_scc1 mg_t2
    s_waitcnt vmcnt(0)
    s_branch mg_t4
mg_t2:
    s_waitcnt vmcnt(3)
    s_branch mg_t4
mg_t0:
    s_waitcnt vmcnt(0)
    s_branch mg_t4
mg_t3:
    s_waitcnt vmcnt(8)
mg_t4:
    v_lshlrev_b32 v76, 16, v32
    v_lshlrev_b32 v77, 16, v36
    v_lshlrev_b32 v78, 16, v40
    v_lshlrev_b32 v79, 16, v44
    v_lshlrev_b32 v80, 16, v48
    v_lshlrev_b32 v81, 16, v52
    v_lshlrev_b32 v82, 16, v56
    v_lshlrev_b32 v83, 16, v60
    v_and_b32 v84, 0xffff0000, v60
    v_lshlrev_b32 v85, 16, v61
    v_and_b32 v86, 0xffff0000, v61
    v_mul_f32 v87, v76, v86
    v_mul_f32 v88, v77, v86
    v_fmac_f32 v87, v77, v85
    v_fmac_f32 v88, v78, v85
    v_fmac_f32 v87, v78, v84
    v_fmac_f32 v88, v79, v84
    v_fmac_f32 v87, v79, v83
    v_fmac_f32 v88, v80, v83
    v_mul_f32 v87, v87, v81
    v_mul_f32 v88, v88, v82
    v_cvt_pk_bf16_f32 v90, v88, v87
    v_and_b32 v76, 0xffff0000, v32
    v_and_b32 v77, 0xffff0000, v36
    v_and_b32 v78, 0xffff0000, v40
    v_and_b32 v79, 0xffff0000, v44
    v_and_b32 v80, 0xffff0000, v48
    v_and_b32 v81, 0xffff0000, v52
    v_and_b32 v82, 0xffff0000, v56
    v_lshlrev_b32 v83, 16, v62
    v_and_b32 v84, 0xffff0000, v62
    v_lshlrev_b32 v85, 16, v63
    v_and_b32 v86, 0xffff0000, v63
    v_mul_f32 v87, v76, v86
    v_mul_f32 v88, v77, v86
    v_fmac_f32 v87, v77, v85
    v_fmac_f32 v88, v78, v85
    v_fmac_f32 v87, v78, v84
    v_fmac_f32 v88, v79, v84
    v_fmac_f32 v87, v79, v83
    v_fmac_f32 v88, v80, v83
    v_mul_f32 v87, v87, v81
    v_mul_f32 v88, v88, v82
    v_cvt_pk_bf16_f32 v91, v88, v87
    v_lshlrev_b32 v76, 16, v33
    v_lshlrev_b32 v77, 16, v37
    v_lshlrev_b32 v78, 16, v41
    v_lshlrev_b32 v79, 16, v45
    v_lshlrev_b32 v80, 16, v49
    v_lshlrev_b32 v81, 16, v53
    v_lshlrev_b32 v82, 16, v57
    v_lshlrev_b32 v83, 16, v64
    v_and_b32 v84, 0xffff0000, v64
    v_lshlrev_b32 v85, 16, v65
    v_and_b32 v86, 0xffff0000, v65
    v_mul_f32 v87, v76, v86
    v_mul_f32 v88, v77, v86
    v_fmac_f32 v87, v77, v85
    v_fmac_f32 v88, v78, v85
    v_fmac_f32 v87, v78, v84
    v_fmac_f32 v88, v79, v84
    v_fmac_f32 v87, v79, v83
    v_fmac_f32 v88, v80, v83
    v_mul_f32 v87, v87, v81
    v_mul_f32 v88, v88, v82
    v_cvt_pk_bf16_f32 v92, v88, v87
    v_and_b32 v76, 0xffff0000, v33
    v_and_b32 v77, 0xffff0000, v37
    v_and_b32 v78, 0xffff0000, v41
    v_and_b32 v79, 0xffff0000, v45
    v_and_b32 v80, 0xffff0000, v49
    v_and_b32 v81, 0xffff0000, v53
    v_and_b32 v82, 0xffff0000, v57
    v_lshlrev_b32 v83, 16, v66
    v_and_b32 v84, 0xffff0000, v66
    v_lshlrev_b32 v85, 16, v67
    v_and_b32 v86, 0xffff0000, v67
    v_mul_f32 v87, v76, v86
    v_mul_f32 v88, v77, v86
    v_fmac_f32 v87, v77, v85
    v_fmac_f32 v88, v78, v85
    v_fmac_f32 v87, v78, v84
    v_fmac_f32 v88, v79, v84
    v_fmac_f32 v87, v79, v83
    v_fmac_f32 v88, v80, v83
    v_mul_f32 v87, v87, v81
    v_mul_f32 v88, v88, v82
    v_cvt_pk_bf16_f32 v93, v88, v87
    v_lshlrev_b32 v76, 16, v34
    v_lshlrev_b32 v77, 16, v38
    v_lshlrev_b32 v78, 16, v42
    v_lshlrev_b32 v79, 16, v46
    v_lshlrev_b32 v80, 16, v50
    v_lshlrev_b32 v81, 16, v54
    v_lshlrev_b32 v82, 16, v58
    v_lshlrev_b32 v83, 16, v68
    v_and_b32 v84, 0xffff0000, v68
    v_lshlrev_b32 v85, 16, v69
    v_and_b32 v86, 0xffff0000, v69
    v_mul_f32 v87, v76, v86
    v_mul_f32 v88, v77, v86
    v_fmac_f32 v87, v77, v85
    v_fmac_f32 v88, v78, v85
    v_fmac_f32 v87, v78, v84
    v_fmac_f32 v88, v79, v84
    v_fmac_f32 v87, v79, v83
    v_fmac_f32 v88, v80, v83
    v_mul_f32 v87, v87, v81
    v_mul_f32 v88, v88, v82
    v_cvt_pk_bf16_f32 v94, v88, v87
    v_and_b32 v76, 0xffff0000, v34
    v_and_b32 v77, 0xffff0000, v38
    v_and_b32 v78, 0xffff0000, v42
    v_and_b32 v79, 0xffff0000, v46
    v_and_b32 v80, 0xffff0000, v50
    v_and_b32 v81, 0xffff0000, v54
    v_and_b32 v82, 0xffff0000, v58
    v_lshlrev_b32 v83, 16, v70
    v_and_b32 v84, 0xffff0000, v70
    v_lshlrev_b32 v85, 16, v71
    v_and_b32 v86, 0xffff0000, v71
    v_mul_f32 v87, v76, v86
    v_mul_f32 v88, v77, v86
    v_fmac_f32 v87, v77, v85
    v_fmac_f32 v88, v78, v85
    v_fmac_f32 v87, v78, v84
    v_fmac_f32 v88, v79, v84
    v_fmac_f32 v87, v79, v83
    v_fmac_f32 v88, v80, v83
    v_mul_f32 v87, v87, v81
    v_mul_f32 v88, v88, v82
    v_cvt_pk_bf16_f32 v95, v88, v87
    v_lshlrev_b32 v76, 16, v35
    v_lshlrev_b32 v77, 16, v39
    v_lshlrev_b32 v78, 16, v43
    v_lshlrev_b32 v79, 16, v47
    v_lshlrev_b32 v80, 16, v51
    v_lshlrev_b32 v81, 16, v55
    v_lshlrev_b32 v82, 16, v59
    v_lshlrev_b32 v83, 16, v72
    v_and_b32 v84, 0xffff0000, v72
    v_lshlrev_b32 v85, 16, v73
    v_and_b32 v86, 0xffff0000, v73
    v_mul_f32 v87, v76, v86
    v_mul_f32 v88, v77, v86
    v_fmac_f32 v87, v77, v85
    v_fmac_f32 v88, v78, v85
    v_fmac_f32 v87, v78, v84
    v_fmac_f32 v88, v79, v84
    v_fmac_f32 v87, v79, v83
    v_fmac_f32 v88, v80, v83
    v_mul_f32 v87, v87, v81
    v_mul_f32 v88, v88, v82
    v_cvt_pk_bf16_f32 v96, v88, v87
    v_and_b32 v76, 0xffff0000, v35
    v_and_b32 v77, 0xffff0000, v39
    v_and_b32 v78, 0xffff0000, v43
    v_and_b32 v79, 0xffff0000, v47
    v_and_b32 v80, 0xffff0000, v51
    v_and_b32 v81, 0xffff0000, v55
    v_and_b32 v82, 0xffff0000, v59
    v_lshlrev_b32 v83, 16, v74
    v_and_b32 v84, 0xffff0000, v74
    v_lshlrev_b32 v85, 16, v75
    v_and_b32 v86, 0xffff0000, v75
    v_mul_f32 v87, v76, v86
    v_mul_f32 v88, v77, v86
    v_fmac_f32 v87, v77, v85
    v_fmac_f32 v88, v78, v85
    v_fmac_f32 v87, v78, v84
    v_fmac_f32 v88, v79, v84
    v_fmac_f32 v87, v79, v83
    v_fmac_f32 v88, v80, v83
    v_mul_f32 v87, v87, v81
    v_mul_f32 v88, v88, v82
    v_cvt_pk_bf16_f32 v97, v88, v87
    ds_write_b32 v25, v90 offset:0
    ds_write_b32 v25, v91 offset:132
    ds_write_b32 v25, v92 offset:264
    ds_write_b32 v25, v93 offset:396
    ds_write_b32 v25, v94 offset:528
    ds_write_b32 v25, v95 offset:660
    ds_write_b32 v25, v96 offset:792
    ds_write_b32 v25, v97 offset:924
    s_cmp_lg_u32 s33, 0
    s_cbranch_scc1 mg_er
    s_waitcnt vmcnt(0)
    v_mov_b32 v6, 1
    v_mov_b32 v7, 0
    s_lshl_b32 s35, s62, 5
    s_add_u32 s35, s35, 4
    s_mov_b64 exec, 1
    buffer_atomic_add v6, v7, s[76:79], s35 offen
    s_mov_b64 exec, -1
mg_er:
    s_waitcnt lgkmcnt(0)
    s_barrier
    v_mov_b32 v7, 143360
    ds_read_b32 v6, v7
    s_waitcnt lgkmcnt(0)
    v_readfirstlane_b32 s63, v6
    s_nop 0
    s_cmp_ge_u32 s63, 32
    s_cbranch_scc1 mega_done
    s_lshl_b32 s30, s62, 1
    s_lshr_b32 s31, s63, 4
    s_add_u32 s30, s30, s31
    s_and_b32 s31, s63, 15
    s_lshl_b32 s34, s30, 7
    s_add_u32 s34, s34, 0x3000000
    s_add_u32 s64, s28, s34
    s_addc_u32 s65, s29, 0
    s_mov_b32 s66, 128
    s_mov_b32 s67, 0x20000
    s_mov_b32 s83, s63
    s_add_u32 s84, s28, 0xc00000
    s_addc_u32 s85, s29, 0
    s_mov_b32 s86, 0x1c0000
    s_mov_b32 s87, 0x20000
    s_mov_b32 s88, s18
    s_mov_b32 s89, s19
    s_mov_b32 s90, 0x1c0000
    s_mov_b32 s91, 0x20000
    s_mov_b32 s92, s20
    s_mov_b32 s93, s21
    s_mov_b32 s94, 0x1c0000
    s_mov_b32 s95, 0x20000
    v_lshlrev_b32 v13, 7, v1
    s_lshr_b32 s96, s63, 3
    s_mul_i32 s96, s96, 448
    s_and_b32 s97, s63, 7
    s_lshl_b32 s97, s97, 3
    s_add_u32 s96, s96, s97
    s_lshl_b32 s96, s96, 10
    s_mul_i32 s97, s63, 7168
    s_and_b32 s96, s31, 7
    s_mul_i32 s96, s96, 229376
    s_lshr_b32 s34, s63, 4
    s_lshl_b32 s34, s34, 1
    s_lshr_b32 s35, s31, 3
    s_add_u32 s34, s34, s35
    s_mul_i32 s34, s34, 57344
    s_add_u32 s96, s96, s34
    s_add_u32 s36, s28, 0x8000
    s_addc_u32 s37, s29, 0
    s_mov_b32 s38, 0x220000
    s_mov_b32 s39, 0x20000
    s_cmp_lg_u32 s33, 0
    s_cbranch_scc1 mg_done

    v_lshrrev_b32 v16, 3, v1
    v_and_b32 v17, 7, v1
    v_mul_u32_u24 v18, 132, v16
    v_lshlrev_b32 v17, 4, v17
    v_add_u32 v18, v18, v17
    ds_read2_b32 v[32:33], v18 offset0:0 offset1:1
    ds_read2_b32 v[34:35], v18 offset0:2 offset1:3
    v_add_u32 v18, 1056, v18
    ds_read2_b32 v[36:37], v18 offset0:0 offset1:1
    ds_read2_b32 v[38:39], v18 offset0:2 offset1:3
    v_add_u32 v18, 1056, v18
    ds_read2_b32 v[40:41], v18 offset0:0 offset1:1
    ds_read2_b32 v[42:43], v18 offset0:2 offset1:3
    v_add_u32 v18, 1056, v18
    ds_read2_b32 v[44:45], v18 offset0:0 offset1:1
    ds_read2_b32 v[46:47], v18 offset0:2 offset1:3
    v_add_u32 v18, 1056, v18
    ds_read2_b32 v[48:49], v18 offset0:0 offset1:1
    ds_read2_b32 v[50:51], v18 offset0:2 offset1:3
    v_add_u32 v18, 1056, v18
    ds_read2_b32 v[52:53], v18 offset0:0 offset1:1
    ds_read2_b32 v[54:55], v18 offset0:2 offset1:3
    v_add_u32 v18, 1056, v18
    ds_read2_b32 v[56:57], v18 offset0:0 offset1:1
    ds_read2_b32 v[58:59], v18 offset0:2 offset1:3
    v_add_u32 v18, 1056, v18
    ds_read2_b32 v[60:61], v18 offset0:0 offset1:1
    ds_read2_b32 v[62:63], v18 offset0:2 offset1:3

    s_lshl_b32 s32, s81, 6
    v_add_u32 v16, s32, v16
    v_mul_u32_u24 v16, 4224, v16
    v_add_u32 v16, v16, v17
    s_lshl_b32 s34, s80, 7
    s_sub_u32 s34, 3968, s34
    s_waitcnt lgkmcnt(0)
    buffer_store_dwordx4 v[32:35], v16, s[36:39], s34 offen sc1
    s_add_u32 s34, s34, 33792
    buffer_store_dwordx4 v[36:39], v16, s[36:39], s34 offen sc1
    s_add_u32 s34, s34, 33792
    buffer_store_dwordx4 v[40:43], v16, s[36:39], s34 offen sc1
    s_add_u32 s34, s34, 33792
    buffer_store_dwordx4 v[44:47], v16, s[36:39], s34 offen sc1
    s_add_u32 s34, s34, 33792
    buffer_store_dwordx4 v[48:51], v16, s[36:39], s34 offen sc1
    s_add_u32 s34, s34, 33792
    buffer_store_dwordx4 v[52:55], v16, s[36:39], s34 offen sc1
    s_add_u32 s34, s34, 33792
    buffer_store_dwordx4 v[56:59], v16, s[36:39], s34 offen sc1
    s_add_u32 s34, s34, 33792
    buffer_store_dwordx4 v[60:63], v16, s[36:39], s34 offen sc1
    s_cmp_lg_u32 s80, 0
    s_cbranch_scc1 mg_np
    v_mov_b32 v28, 0
    v_mov_b32 v29, 0
    v_mov_b32 v30, 0
    v_mov_b32 v31, 0
    s_mov_b32 s34, 4096
    buffer_store_dwordx4 v[28:31], v16, s[36:39], s34 offen sc1
    s_add_u32 s34, s34, 33792
    buffer_store_dwordx4 v[28:31], v16, s[36:39], s34 offen sc1
    s_add_u32 s34, s34, 33792
    buffer_store_dwordx4 v[28:31], v16, s[36:39], s34 offen sc1
    s_add_u32 s34, s34, 33792
    buffer_store_dwordx4 v[28:31], v16, s[36:39], s34 offen sc1
    s_add_u32 s34, s34, 33792
    buffer_store_dwordx4 v[28:31], v16, s[36:39], s34 offen sc1
    s_add_u32 s34, s34, 33792
    buffer_store_dwordx4 v[28:31], v16, s[36:39], s34 offen sc1
    s_add_u32 s34, s34, 33792
    buffer_store_dwordx4 v[28:31], v16, s[36:39], s34 offen sc1
    s_add_u32 s34, s34, 33792
    buffer_store_dwordx4 v[28:31], v16, s[36:39], s34 offen sc1
mg_np:
mg_done:
    s_cmp_lg_u32 s33, 3
    s_cbranch_scc1 w2e_s
    s_add_u32 s48, s28, 0xc00000
    s_addc_u32 s49, s29, 0
    s_mov_b32 s50, 0x1c0000
    s_mov_b32 s51, 0x20000
    v_lshrrev_b32 v16, 4, v1
    v_and_b32 v17, 1, v16
    v_lshrrev_b32 v18, 1, v16
    v_bfe_u32 v19, v1, 2, 2
    v_and_b32 v20, 3, v1
    v_lshlrev_b32 v21, 2, v18
    v_add_u32 v21, v21, v19
    v_lshlrev_b32 v21, 6, v21
    v_lshlrev_b32 v22, 5, v17
    v_add_u32 v21, v21, v22
    v_lshlrev_b32 v22, 3, v20
    v_add_u32 v21, v21, v22
    v_add_u32 v21, 32768, v21
    s_lshr_b32 s34, s2, 5
    s_mul_i32 s34, s34, 112
    s_and_b32 s35, s2, 15
    s_mul_i32 s35, s35, 7
    s_add_u32 s34, s34, s35
    s_lshl_b32 s34, s34, 1
    s_bfe_u32 s35, s2, 0x10004
    s_add_u32 s34, s34, s35
    s_lshl_b32 s52, s34, 10
    s_waitcnt vmcnt(0)
    ds_read_b64_tr_b16 v[32:33], v21 offset:0
    ds_read_b64_tr_b16 v[34:35], v21 offset:512
    ds_read_b64_tr_b16 v[36:37], v21 offset:1024
    ds_read_b64_tr_b16 v[38:39], v21 offset:1536
    ds_read_b64_tr_b16 v[40:41], v21 offset:2048
    ds_read_b64_tr_b16 v[42:43], v21 offset:2560
    ds_read_b64_tr_b16 v[44:45], v21 offset:3072
    ds_read_b64_tr_b16 v[46:47], v21 offset:3584
    ds_read_b64_tr_b16 v[48:49], v21 offset:4096
    ds_read_b64_tr_b16 v[50:51], v21 offset:4608
    ds_read_b64_tr_b16 v[52:53], v21 offset:5120
    ds_read_b64_tr_b16 v[54:55], v21 offset:5632
    ds_read_b64_tr_b16 v[56:57], v21 offset:6144
    ds_read_b64_tr_b16 v[58:59], v21 offset:6656
    s_waitcnt lgkmcnt(0)
    buffer_store_dwordx4 v[32:35], v2, s[48:51], s52 offen sc1
    s_add_u32 s52, s52, 2048
    buffer_store_dwordx4 v[36:39], v2, s[48:51], s52 offen sc1
    s_add_u32 s52, s52, 2048
    buffer_store_dwordx4 v[40:43], v2, s[48:51], s52 offen sc1
    s_add_u32 s52, s52, 2048
    buffer_store_dwordx4 v[44:47], v2, s[48:51], s52 offen sc1
    s_add_u32 s52, s52, 2048
    buffer_store_dwordx4 v[48:51], v2, s[48:51], s52 offen sc1
    s_add_u32 s52, s52, 2048
    buffer_store_dwordx4 v[52:55], v2, s[48:51], s52 offen sc1
    s_add_u32 s52, s52, 2048
    buffer_store_dwordx4 v[56:59], v2, s[48:51], s52 offen sc1
w2e_s:
    s_mov_b32 s40, s12
    s_mov_b32 s41, s13
    s_mov_b32 s42, 0x200000
    s_mov_b32 s43, 0x20000
    s_lshr_b32 s34, s33, 1
    s_and_b32 s35, s33, 1
    s_lshl_b32 s52, s2, 1
    s_add_u32 s52, s52, s34
    s_lshl_b32 s56, s52, 12
    s_lshl_b32 s58, s35, 11
    s_add_u32 s56, s56, s58
    buffer_load_dwordx4 v[100:103], v2, s[40:43], s56 offen
    buffer_load_dwordx4 v[104:107], v2, s[40:43], s56 offen offset:1024
    s_waitcnt vmcnt(0)
    s_barrier
    s_cmp_lg_u32 s33, 0
    s_cbranch_scc1 g0_pf
    s_lshl_b32 s34, s62, 7
    s_lshl_b32 s35, s63, 2
    s_add_u32 s35, s35, s34
    v_mov_b32 v6, 1
    v_mov_b32 v7, 0
    s_mov_b64 exec, 1
    buffer_store_dword v6, v7, s[72:75], s35 offen
    s_mov_b64 exec, -1
    s_mov_b32 s69, 0
    s_cmp_lg_u32 s63, 0
    s_cbranch_scc1 g0_nl
    v_and_b32 v16, 7, v1
    v_lshlrev_b32 v16, 5, v16
    v_add_u32 v16, 4, v16
g0_r:
    buffer_load_dword v18, v16, s[76:79], 0 offen sc1
    s_add_u32 s69, s69, 1
    s_cmp_gt_u32 s69, 200000
    s_cbranch_scc1 g0_w
    s_waitcnt vmcnt(0)
    v_cmp_ne_u32 vcc, 32, v18
    s_nop 0
    s_cmp_eq_u64 vcc, 0
    s_cbranch_scc1 g0_rok
    s_sleep 4
    s_branch g0_r
g0_rok:
    v_and_b32 v16, 31, v1
    v_lshlrev_b32 v16, 2, v16
g0_p1:
    buffer_load_dword v17, v16, s[72:75], s34 offen sc1
    s_add_u32 s69, s69, 1
    s_cmp_gt_u32 s69, 200000
    s_cbranch_scc1 g0_w
    s_waitcnt vmcnt(0)
    v_cmp_gt_u32 vcc, 1, v17
    s_nop 0
    s_cmp_lg_u64 vcc, 0
    s_cbranch_scc1 g0_p1

    v_and_b32 v16, 7, v1
    v_lshlrev_b32 v16, 7, v16
    s_lshl_b32 s35, s62, 2
    s_add_u32 s35, s35, 1024
    s_mov_b64 exec, 0xff
    buffer_store_dword v6, v16, s[72:75], s35 offen sc1
    s_mov_b64 exec, -1
    v_and_b32 v16, 7, v1
    v_lshlrev_b32 v16, 2, v16
    s_add_u32 s35, s34, 1024
g0_p2:
    buffer_load_dword v17, v16, s[72:75], s35 offen sc1
    s_add_u32 s69, s69, 1
    s_cmp_gt_u32 s69, 200000
    s_cbranch_scc1 g0_w
    s_waitcnt vmcnt(0)
    v_cmp_gt_u32 vcc, 1, v17
    s_nop 0
    s_cmp_lg_u64 vcc, 0
    s_cbranch_scc1 g0_p2
    v_and_b32 v16, 31, v1
    v_lshlrev_b32 v16, 2, v16
    s_add_u32 s35, s34, 2048
    s_mov_b64 exec, 0xffffffff
    buffer_store_dword v6, v16, s[72:75], s35 offen
    s_mov_b64 exec, -1
    s_branch g0_ok
g0_nl:
    s_add_u32 s35, s35, 2048
g0_p3:
    buffer_load_dword v17, v7, s[72:75], s35 offen sc1
    s_add_u32 s69, s69, 1
    s_cmp_gt_u32 s69, 200000
    s_cbranch_scc1 g0_w
    s_waitcnt vmcnt(0)
    v_cmp_gt_u32 vcc, 1, v17
    s_nop 0
    s_cmp_lg_u64 vcc, 0
    s_cbranch_scc1 g0_p3
g0_ok:
    s_branch g0_w
g0_pf:
    s_cmp_lg_u32 s33, 1
    s_cbranch_scc1 wa_1
    v_min_u32 v14, 7040, v13
    v_add_u32 v14, 0, v14
    buffer_load_dword v3, v14, s[88:91], s97 offen
    v_min_u32 v14, 7040, v13
    v_add_u32 v14, 0, v14
    buffer_load_dword v3, v14, s[92:95], s97 offen
    s_waitcnt vmcnt(1)
    v_min_u32 v14, 7040, v13
    v_add_u32 v14, 229376, v14
    buffer_load_dword v3, v14, s[88:91], s97 offen
    s_waitcnt vmcnt(1)
    v_min_u32 v14, 7040, v13
    v_add_u32 v14, 229376, v14
    buffer_load_dword v3, v14, s[92:95], s97 offen
    s_waitcnt vmcnt(1)
    v_min_u32 v14, 7040, v13
    v_add_u32 v14, 458752, v14
    buffer_load_dword v3, v14, s[88:91], s97 offen
    s_waitcnt vmcnt(1)
    v_min_u32 v14, 7040, v13
    v_add_u32 v14, 458752, v14
    buffer_load_dword v3, v14, s[92:95], s97 offen
    s_waitcnt vmcnt(1)
    v_min_u32 v14, 7040, v13
    v_add_u32 v14, 688128, v14
    buffer_load_dword v3, v14, s[88:91], s97 offen
    s_waitcnt vmcnt(1)
    v_min_u32 v14, 7040, v13
    v_add_u32 v14, 688128, v14
    buffer_load_dword v3, v14, s[92:95], s97 offen
    s_waitcnt vmcnt(1)
wa_1:
    s_cmp_lg_u32 s33, 2
    s_cbranch_scc1 wa_m
    s_cmp_lt_u32 s2, 128
    s_cselect_b32 s40, s18, s20
    s_cselect_b32 s41, s19, s21
    s_mov_b32 s42, 1835008
    s_mov_b32 s43, 0x20000
    s_and_b32 s34, s2, 127
    s_lshl_b32 s34, s34, 1
    s_add_u32 s34, s34, 256
    s_mul_i32 s34, s34, 3584
    v_min_u32 v14, 7040, v13
    buffer_load_dword v3, v14, s[40:43], s34 offen
wa_m:
g0_w:
    s_barrier
    v_mov_b32 v7, 0
    s_add_u32 s36, s28, 0x8000
    s_addc_u32 s37, s29, 0
    s_mov_b32 s38, 0x220000
    s_mov_b32 s39, 0x20000
    s_mov_b32 s40, s12
    s_mov_b32 s41, s13
    s_mov_b32 s42, 0x200000
    s_mov_b32 s43, 0x20000
    s_add_u32 s44, s28, 0x408000
    s_addc_u32 s45, s29, 0
    s_mov_b32 s46, 0x200000
    s_mov_b32 s47, 0x20000

    s_lshr_b32 s34, s33, 1
    s_and_b32 s35, s33, 1
    s_lshl_b32 s52, s2, 1
    s_add_u32 s52, s52, s34
    s_lshl_b32 s53, s52, 1
    s_and_b32 s54, s53, 0xfffffffc
    s_load_dword s55, s[14:15], s54
    s_mul_i32 s56, s52, 4224
    v_and_b32 v16, 127, v0
    v_lshlrev_b32 v16, 4, v16
    buffer_load_dwordx4 v[20:23], v16, s[36:39], s56 offen sc1
    buffer_load_dwordx4 v[24:27], v16, s[36:39], s56 offen offset:16 sc1
    buffer_load_dwordx4 v[28:31], v16, s[36:39], s56 offen offset:2048 sc1
    buffer_load_dwordx4 v[32:35], v16, s[36:39], s56 offen offset:2064 sc1

    s_mul_i32 s58, s34, 7600
    s_add_u32 s58, s58, 66560
    s_lshl_b32 s59, s35, 7
    v_add_u32 v17, s59, v1
    v_min_u32 v18, 154, v17
    v_lshlrev_b32 v18, 4, v18
    v_add_u32 v18, s58, v18
    v_add_u32 v19, 64, v17
    v_min_u32 v19, 154, v19
    v_lshlrev_b32 v19, 4, v19
    v_add_u32 v19, s58, v19
    v_mov_b32 v44, 0
    v_mov_b32 v45, 0
    v_mov_b32 v46, 0
    v_mov_b32 v47, 0
    ds_write_b128 v18, v[44:47]
    ds_write_b128 v19, v[44:47]
    v_lshrrev_b32 v17, 2, v1
    v_and_b32 v17, 7, v17
    v_mul_u32_u24 v17, 4160, v17
    v_and_b32 v18, 3, v1
    v_lshlrev_b32 v18, 4, v18
    v_add_u32 v17, v17, v18
    s_mul_i32 s59, s34, 33280
    s_add_u32 s60, s59, 4096
    v_add_u32 v17, s60, v17
    ds_write_b128 v17, v[44:47]
    v_lshrrev_b32 v18, 2, v1
    s_lshl_b32 s60, s35, 5
    s_add_u32 s60, s60, 31
    v_add_u32 v18, s60, v18
    v_mul_u32_u24 v18, 80, v18
    v_and_b32 v19, 3, v1
    v_lshlrev_b32 v19, 4, v19
    v_add_u32 v18, v18, v19
    v_add_u32 v18, s58, v18
    v_add_u32 v16, s59, v16
    s_cmp_lg_u32 s33, 0
    s_cbranch_scc1 T_1
    v_add_u32 v14, 0, v13
    buffer_load_dword v3, v14, s[84:87], s96 offen
T_1:
    s_cmp_lg_u32 s33, 1
    s_cbranch_scc1 T_2
    v_add_u32 v14, 8192, v13
    buffer_load_dword v3, v14, s[84:87], s96 offen
T_2:
    s_cmp_ge_u32 s33, 2
    s_cbranch_scc1 cv_w0
    s_waitcnt vmcnt(1)
    s_branch cv_w1
cv_w0:
    s_waitcnt vmcnt(0)
cv_w1:
    s_cmp_lg_u32 s33, 2
    s_cbranch_scc1 T_3
    v_add_u32 v14, 16384, v13
    buffer_load_dword v3, v14, s[84:87], s96 offen
T_3:
    s_cmp_lg_u32 s33, 3
    s_cbranch_scc1 T_4
    v_add_u32 v14, 24576, v13
    buffer_load_dword v3, v14, s[84:87], s96 offen
T_4:
    ds_write_b128 v18, v[100:103]
    ds_write_b128 v18, v[104:107] offset:1280
    v_mov_b32 v48, v21
    v_mov_b32 v49, v22
    v_mov_b32 v50, v23
    v_mov_b32 v51, v24
    v_mov_b32 v52, v25
    v_mov_b32 v53, v26
    v_alignbit_b32 v56, v21, v20, 16
    v_alignbit_b32 v57, v22, v21, 16
    v_alignbit_b32 v58, v23, v22, 16
    v_alignbit_b32 v59, v24, v23, 16
    v_alignbit_b32 v60, v25, v24, 16
    v_alignbit_b32 v61, v26, v25, 16
    v_alignbit_b32 v62, v27, v26, 16
    v_alignbit_b32 v64, v22, v21, 16
    v_alignbit_b32 v65, v23, v22, 16
    v_alignbit_b32 v66, v24, v23, 16
    v_alignbit_b32 v67, v25, v24, 16
    v_alignbit_b32 v68, v26, v25, 16
    v_alignbit_b32 v69, v27, v26, 16
    ds_write_b128 v16, v[20:23] offset:0
    ds_write_b128 v16, v[56:59] offset:4160
    ds_write_b128 v16, v[48:51] offset:8320
    ds_write_b128 v16, v[64:67] offset:12480
    ds_write_b128 v16, v[22:25] offset:16640
    ds_write_b128 v16, v[58:61] offset:20800
    ds_write_b128 v16, v[50:53] offset:24960
    ds_write_b128 v16, v[66:69] offset:29120
    v_mov_b32 v48, v29
    v_mov_b32 v49, v30
    v_mov_b32 v50, v31
    v_mov_b32 v51, v32
    v_mov_b32 v52, v33
    v_mov_b32 v53, v34
    v_alignbit_b32 v56, v29, v28, 16
    v_alignbit_b32 v57, v30, v29, 16
    v_alignbit_b32 v58, v31, v30, 16
    v_alignbit_b32 v59, v32, v31, 16
    v_alignbit_b32 v60, v33, v32, 16
    v_alignbit_b32 v61, v34, v33, 16
    v_alignbit_b32 v62, v35, v34, 16
    v_alignbit_b32 v64, v30, v29, 16
    v_alignbit_b32 v65, v31, v30, 16
    v_alignbit_b32 v66, v32, v31, 16
    v_alignbit_b32 v67, v33, v32, 16
    v_alignbit_b32 v68, v34, v33, 16
    v_alignbit_b32 v69, v35, v34, 16
    ds_write_b128 v16, v[28:31] offset:2048
    ds_write_b128 v16, v[56:59] offset:6208
    ds_write_b128 v16, v[48:51] offset:10368
    ds_write_b128 v16, v[64:67] offset:14528
    ds_write_b128 v16, v[30:33] offset:18688
    ds_write_b128 v16, v[58:61] offset:22848
    ds_write_b128 v16, v[50:53] offset:27008
    ds_write_b128 v16, v[66:69] offset:31168

    v_and_b32 v8, 31, v1
    v_lshrrev_b32 v9, 5, v1
    v_and_b32 v17, 7, v8
    v_sub_u32 v17, 7, v17
    v_mul_u32_u24 v17, 4160, v17
    v_lshrrev_b32 v18, 3, v8
    v_sub_u32 v18, v9, v18
    v_add_u32 v18, 255, v18
    v_lshlrev_b32 v18, 4, v18
    v_add_u32 v17, v17, v18
    s_lshl_b32 s60, s35, 10
    s_sub_u32 s59, s59, s60
    s_sub_u32 s59, s59, 3008
    v_add_u32 v10, s59, v17
    v_mul_u32_u24 v17, 80, v8
    v_lshlrev_b32 v18, 4, v9
    v_add_u32 v17, v17, v18
    s_mul_i32 s60, s35, 1280
    s_sub_u32 s60, s58, s60
    s_add_u32 s60, s60, 1280
    v_add_u32 v11, s60, v17
    s_add_u32 s48, s28, 0xc00000
    s_addc_u32 s49, s29, 0
    s_mov_b32 s50, 0x1c0000
    s_mov_b32 s51, 0x20000
    s_and_b32 s53, s31, 7
    s_mul_i32 s53, s53, 112
    s_mul_i32 s56, s33, 28
    s_add_u32 s53, s53, s56
    s_lshl_b32 s61, s53, 11
    s_lshr_b32 s56, s33, 1
    s_lshl_b32 s56, s56, 10
    s_xor_b32 s82, s56, 1024
    s_add_u32 s82, s82, s61
    s_add_u32 s61, s61, s56
    s_cmp_lg_u32 s33, 0
    s_cbranch_scc1 T_5
    v_add_u32 v14, 32768, v13
    buffer_load_dword v3, v14, s[84:87], s96 offen
T_5:
    s_waitcnt lgkmcnt(0)
    s_barrier
    s_mov_b32 s40, s4
    s_mov_b32 s41, s5
    s_mov_b32 s42, 0x200000
    s_mov_b32 s43, 0x20000
    s_lshl_b32 s56, s30, 7
    s_lshl_b32 s57, s31, 3
    s_add_u32 s56, s56, s57
    s_lshl_b32 s57, s33, 1
    s_add_u32 s56, s56, s57
    s_lshl_b32 s57, s56, 10
    buffer_load_dwordx4 v[160:163], v2, s[40:43], s57 offen
    buffer_load_dwordx4 v[164:167], v2, s[40:43], s57 offen offset:1024
    ds_read_b128 v[108:111], v10 offset:3008
    ds_read_b128 v[112:115], v11 offset:1200
    ds_read_b128 v[116:119], v11 offset:3760
    ds_read_b128 v[120:123], v10 offset:960
    ds_read_b128 v[124:127], v10 offset:3040
    ds_read_b128 v[128:131], v11 offset:1232
    ds_read_b128 v[132:135], v11 offset:3792
    ds_read_b128 v[136:139], v10 offset:992
    ds_read_b128 v[140:143], v10 offset:2944
    ds_read_b128 v[144:147], v11 offset:1120
    ds_read_b128 v[148:151], v11 offset:3680
    ds_read_b128 v[152:155], v10 offset:896
    s_waitcnt lgkmcnt(10)
    v_mfma_f32_32x32x16_bf16 v[64:79], v[108:111], v[112:115], 0
    s_waitcnt lgkmcnt(9)
    v_mfma_f32_32x32x16_bf16 v[80:95], v[108:111], v[116:119], 0
    s_waitcnt lgkmcnt(8)
    v_mfma_f32_32x32x16_bf16 v[80:95], v[120:123], v[112:115], v[80:95]
    ds_read_b128 v[108:111], v10 offset:2976
    ds_read_b128 v[112:115], v11 offset:1152
    ds_read_b128 v[116:119], v11 offset:3712
    ds_read_b128 v[120:123], v10 offset:928
    s_waitcnt lgkmcnt(10)
    v_mfma_f32_32x32x16_bf16 v[64:79], v[124:127], v[128:131], v[64:79]
    s_waitcnt lgkmcnt(9)
    v_mfma_f32_32x32x16_bf16 v[80:95], v[124:127], v[132:135], v[80:95]
    s_waitcnt lgkmcnt(8)
    v_mfma_f32_32x32x16_bf16 v[80:95], v[136:139], v[128:131], v[80:95]
    ds_read_b128 v[124:127], v10 offset:2880
    ds_read_b128 v[128:131], v11 offset:1040
    ds_read_b128 v[132:135], v11 offset:3600
    ds_read_b128 v[136:139], v10 offset:832
    s_waitcnt lgkmcnt(10)
    v_mfma_f32_32x32x16_bf16 v[64:79], v[140:143], v[144:147], v[64:79]
    s_waitcnt lgkmcnt(9)
    v_mfma_f32_32x32x16_bf16 v[80:95], v[140:143], v[148:151], v[80:95]
    s_waitcnt lgkmcnt(8)
    v_mfma_f32_32x32x16_bf16 v[80:95], v[152:155], v[144:147], v[80:95]
    ds_read_b128 v[140:143], v10 offset:2912
    ds_read_b128 v[144:147], v11 offset:1072
    ds_read_b128 v[148:151], v11 offset:3632
    ds_read_b128 v[152:155], v10 offset:864
    s_waitcnt lgkmcnt(10)
    v_mfma_f32_32x32x16_bf16 v[64:79], v[108:111], v[112:115], v[64:79]
    s_waitcnt lgkmcnt(9)
    v_mfma_f32_32x32x16_bf16 v[80:95], v[108:111], v[116:119], v[80:95]
    s_waitcnt lgkmcnt(8)
    v_mfma_f32_32x32x16_bf16 v[80:95], v[120:123], v[112:115], v[80:95]
    s_cmp_lg_u32 s33, 0
    s_cbranch_scc1 T_6
    v_add_u32 v14, 40960, v13
    buffer_load_dword v3, v14, s[84:87], s96 offen
T_6:
    ds_read_b128 v[108:111], v10 offset:2816
    ds_read_b128 v[112:115], v11 offset:960
    ds_read_b128 v[116:119], v11 offset:3520
    ds_read_b128 v[120:123], v10 offset:768
    s_waitcnt lgkmcnt(10)
    v_mfma_f32_32x32x16_bf16 v[64:79], v[124:127], v[128:131], v[64:79]
    s_waitcnt lgkmcnt(9)
    v_mfma_f32_32x32x16_bf16 v[80:95], v[124:127], v[132:135], v[80:95]
    s_waitcnt lgkmcnt(8)
    v_mfma_f32_32x32x16_bf16 v[80:95], v[136:139], v[128:131], v[80:95]
    ds_read_b128 v[124:127], v10 offset:2848
    ds_read_b128 v[128:131], v11 offset:992
    ds_read_b128 v[132:135], v11 offset:3552
    ds_read_b128 v[136:139], v10 offset:800
    s_waitcnt lgkmcnt(10)
    v_mfma_f32_32x32x16_bf16 v[64:79], v[140:143], v[144:147], v[64:79]
    s_waitcnt lgkmcnt(9)
    v_mfma_f32_32x32x16_bf16 v[80:95], v[140:143], v[148:151], v[80:95]
    s_waitcnt lgkmcnt(8)
    v_mfma_f32_32x32x16_bf16 v[80:95], v[152:155], v[144:147], v[80:95]
    ds_read_b128 v[140:143], v10 offset:2752
    ds_read_b128 v[144:147], v11 offset:880
    ds_read_b128 v[148:151], v11 offset:3440
    ds_read_b128 v[152:155], v10 offset:704
    s_waitcnt lgkmcnt(10)
    v_mfma_f32_32x32x16_bf16 v[64:79], v[108:111], v[112:115], v[64:79]
    buffer_load_dwordx4 a[0:3], v2, s[48:51], s61 offen
    s_add_u32 s61, s61, 2048
    s_waitcnt lgkmcnt(9)
    v_mfma_f32_32x32x16_bf16 v[80:95], v[108:111], v[116:119], v[80:95]
    s_waitcnt lgkmcnt(8)
    v_mfma_f32_32x32x16_bf16 v[80:95], v[120:123], v[112:115], v[80:95]
    ds_read_b128 v[108:111], v10 offset:2784
    ds_read_b128 v[112:115], v11 offset:912
    ds_read_b128 v[116:119], v11 offset:3472
    ds_read_b128 v[120:123], v10 offset:736
    s_waitcnt lgkmcnt(10)
    v_mfma_f32_32x32x16_bf16 v[64:79], v[124:127], v[128:131], v[64:79]
    buffer_load_dwordx4 a[4:7], v2, s[48:51], s82 offen
    s_add_u32 s82, s82, 2048
    s_waitcnt lgkmcnt(9)
    v_mfma_f32_32x32x16_bf16 v[80:95], v[124:127], v[132:135], v[80:95]
    s_waitcnt lgkmcnt(8)
    v_mfma_f32_32x32x16_bf16 v[80:95], v[136:139], v[128:131], v[80:95]
    ds_read_b128 v[124:127], v10 offset:2688
    ds_read_b128 v[128:131], v11 offset:800
    ds_read_b128 v[132:135], v11 offset:3360
    ds_read_b128 v[136:139], v10 offset:640
    s_waitcnt lgkmcnt(10)
    v_mfma_f32_32x32x16_bf16 v[64:79], v[140:143], v[144:147], v[64:79]
    buffer_load_dwordx4 a[8:11], v2, s[48:51], s61 offen
    s_add_u32 s61, s61, 2048
    s_waitcnt lgkmcnt(9)
    v_mfma_f32_32x32x16_bf16 v[80:95], v[140:143], v[148:151], v[80:95]
    buffer_load_dwordx4 a[12:15], v2, s[48:51], s82 offen
    s_add_u32 s82, s82, 2048
    s_waitcnt lgkmcnt(8)
    v_mfma_f32_32x32x16_bf16 v[80:95], v[152:155], v[144:147], v[80:95]
    ds_read_b128 v[140:143], v10 offset:2720
    ds_read_b128 v[144:147], v11 offset:832
    ds_read_b128 v[148:151], v11 offset:3392
    ds_read_b128 v[152:155], v10 offset:672
    s_waitcnt lgkmcnt(10)
    v_mfma_f32_32x32x16_bf16 v[64:79], v[108:111], v[112:115], v[64:79]
    buffer_load_dwordx4 a[16:19], v2, s[48:51], s61 offen
    s_add_u32 s61, s61, 2048
    s_waitcnt lgkmcnt(9)
    v_mfma_f32_32x32x16_bf16 v[80:95], v[108:111], v[116:119], v[80:95]
    buffer_load_dwordx4 a[20:23], v2, s[48:51], s82 offen
    s_add_u32 s82, s82, 2048
    s_waitcnt lgkmcnt(8)
    v_mfma_f32_32x32x16_bf16 v[80:95], v[120:123], v[112:115], v[80:95]
    s_cmp_lg_u32 s33, 1
    s_cbranch_scc1 T_7
    v_add_u32 v14, 49152, v13
    buffer_load_dword v3, v14, s[84:87], s96 offen
T_7:
    ds_read_b128 v[108:111], v10 offset:2624
    ds_read_b128 v[112:115], v11 offset:720
    ds_read_b128 v[116:119], v11 offset:3280
    ds_read_b128 v[120:123], v10 offset:576
    s_waitcnt lgkmcnt(10)
    v_mfma_f32_32x32x16_bf16 v[64:79], v[124:127], v[128:131], v[64:79]
    buffer_load_dwordx4 a[24:27], v2, s[48:51], s61 offen
    s_add_u32 s61, s61, 2048
    s_waitcnt lgkmcnt(9)
    v_mfma_f32_32x32x16_bf16 v[80:95], v[124:127], v[132:135], v[80:95]
    buffer_load_dwordx4 a[28:31], v2, s[48:51], s82 offen
    s_add_u32 s82, s82, 2048
    s_waitcnt lgkmcnt(8)
    v_mfma_f32_32x32x16_bf16 v[80:95], v[136:139], v[128:131], v[80:95]
    ds_read_b128 v[124:127], v10 offset:2656
    ds_read_b128 v[128:131], v11 offset:752
    ds_read_b128 v[132:135], v11 offset:3312
    ds_read_b128 v[136:139], v10 offset:608
    s_waitcnt lgkmcnt(10)
    v_mfma_f32_32x32x16_bf16 v[64:79], v[140:143], v[144:147], v[64:79]
    buffer_load_dwordx4 a[32:35], v2, s[48:51], s61 offen
    s_add_u32 s61, s61, 2048
    s_waitcnt lgkmcnt(9)
    v_mfma_f32_32x32x16_bf16 v[80:95], v[140:143], v[148:151], v[80:95]
    s_waitcnt lgkmcnt(8)
    v_mfma_f32_32x32x16_bf16 v[80:95], v[152:155], v[144:147], v[80:95]
    ds_read_b128 v[140:143], v10 offset:2560
    ds_read_b128 v[144:147], v11 offset:640
    ds_read_b128 v[148:151], v11 offset:3200
    ds_read_b128 v[152:155], v10 offset:512
    s_waitcnt lgkmcnt(10)
    v_mfma_f32_32x32x16_bf16 v[64:79], v[108:111], v[112:115], v[64:79]
    buffer_load_dwordx4 a[36:39], v2, s[48:51], s82 offen
    s_add_u32 s82, s82, 2048
    s_waitcnt lgkmcnt(9)
    v_mfma_f32_32x32x16_bf16 v[80:95], v[108:111], v[116:119], v[80:95]
    buffer_load_dwordx4 a[40:43], v2, s[48:51], s61 offen
    s_add_u32 s61, s61, 2048
    s_waitcnt lgkmcnt(8)
    v_mfma_f32_32x32x16_bf16 v[80:95], v[120:123], v[112:115], v[80:95]
    ds_read_b128 v[108:111], v10 offset:2592
    ds_read_b128 v[112:115], v11 offset:672
    ds_read_b128 v[116:119], v11 offset:3232
    ds_read_b128 v[120:123], v10 offset:544
    s_waitcnt lgkmcnt(10)
    v_mfma_f32_32x32x16_bf16 v[64:79], v[124:127], v[128:131], v[64:79]
    buffer_load_dwordx4 a[44:47], v2, s[48:51], s82 offen
    s_add_u32 s82, s82, 2048
    s_waitcnt lgkmcnt(9)
    v_mfma_f32_32x32x16_bf16 v[80:95], v[124:127], v[132:135], v[80:95]
    buffer_load_dwordx4 a[48:51], v2, s[48:51], s61 offen
    s_add_u32 s61, s61, 2048
    s_waitcnt lgkmcnt(8)
    v_mfma_f32_32x32x16_bf16 v[80:95], v[136:139], v[128:131], v[80:95]
    ds_read_b128 v[124:127], v10 offset:2496
    ds_read_b128 v[128:131], v11 offset:560
    ds_read_b128 v[132:135], v11 offset:3120
    ds_read_b128 v[136:139], v10 offset:448
    s_waitcnt lgkmcnt(10)
    v_mfma_f32_32x32x16_bf16 v[64:79], v[140:143], v[144:147], v[64:79]
    buffer_load_dwordx4 a[52:55], v2, s[48:51], s82 offen
    s_add_u32 s82, s82, 2048
    s_waitcnt lgkmcnt(9)
    v_mfma_f32_32x32x16_bf16 v[80:95], v[140:143], v[148:151], v[80:95]
    buffer_load_dwordx4 a[56:59], v2, s[48:51], s61 offen
    s_add_u32 s61, s61, 2048
    s_waitcnt lgkmcnt(8)
    v_mfma_f32_32x32x16_bf16 v[80:95], v[152:155], v[144:147], v[80:95]
    ds_read_b128 v[140:143], v10 offset:2528
    ds_read_b128 v[144:147], v11 offset:592
    ds_read_b128 v[148:151], v11 offset:3152
    ds_read_b128 v[152:155], v10 offset:480
    s_waitcnt lgkmcnt(10)
    v_mfma_f32_32x32x16_bf16 v[64:79], v[108:111], v[112:115], v[64:79]
    buffer_load_dwordx4 a[60:63], v2, s[48:51], s82 offen
    s_add_u32 s82, s82, 2048
    s_waitcnt lgkmcnt(9)
    v_mfma_f32_32x32x16_bf16 v[80:95], v[108:111], v[116:119], v[80:95]
    s_waitcnt lgkmcnt(8)
    v_mfma_f32_32x32x16_bf16 v[80:95], v[120:123], v[112:115], v[80:95]
    ds_read_b128 v[108:111], v10 offset:2432
    ds_read_b128 v[112:115], v11 offset:480
    ds_read_b128 v[116:119], v11 offset:3040
    ds_read_b128 v[120:123], v10 offset:384
    s_waitcnt lgkmcnt(10)
    v_mfma_f32_32x32x16_bf16 v[64:79], v[124:127], v[128:131], v[64:79]
    buffer_load_dwordx4 a[64:67], v2, s[48:51], s61 offen
    s_add_u32 s61, s61, 2048
    s_waitcnt lgkmcnt(9)
    v_mfma_f32_32x32x16_bf16 v[80:95], v[124:127], v[132:135], v[80:95]
    buffer_load_dwordx4 a[68:71], v2, s[48:51], s82 offen
    s_add_u32 s82, s82, 2048
    s_waitcnt lgkmcnt(8)
    v_mfma_f32_32x32x16_bf16 v[80:95], v[136:139], v[128:131], v[80:95]
    ds_read_b128 v[124:127], v10 offset:2464
    ds_read_b128 v[128:131], v11 offset:512
    ds_read_b128 v[132:135], v11 offset:3072
    ds_read_b128 v[136:139], v10 offset:416
    s_waitcnt lgkmcnt(10)
    v_mfma_f32_32x32x16_bf16 v[64:79], v[140:143], v[144:147], v[64:79]
    buffer_load_dwordx4 a[72:75], v2, s[48:51], s61 offen
    s_add_u32 s61, s61, 2048
    s_waitcnt lgkmcnt(9)
    v_mfma_f32_32x32x16_bf16 v[80:95], v[140:143], v[148:151], v[80:95]
    buffer_load_dwordx4 a[76:79], v2, s[48:51], s82 offen
    s_add_u32 s82, s82, 2048
    s_waitcnt lgkmcnt(8)
    v_mfma_f32_32x32x16_bf16 v[80:95], v[152:155], v[144:147], v[80:95]
    ds_read_b128 v[140:143], v10 offset:2368
    ds_read_b128 v[144:147], v11 offset:400
    ds_read_b128 v[148:151], v11 offset:2960
    ds_read_b128 v[152:155], v10 offset:320
    s_waitcnt lgkmcnt(10)
    v_mfma_f32_32x32x16_bf16 v[64:79], v[108:111], v[112:115], v[64:79]
    buffer_load_dwordx4 a[80:83], v2, s[48:51], s61 offen
    s_add_u32 s61, s61, 2048
    s_waitcnt lgkmcnt(9)
    v_mfma_f32_32x32x16_bf16 v[80:95], v[108:111], v[116:119], v[80:95]
    buffer_load_dwordx4 a[84:87], v2, s[48:51], s82 offen
    s_add_u32 s82, s82, 2048
    s_waitcnt lgkmcnt(8)
    v_mfma_f32_32x32x16_bf16 v[80:95], v[120:123], v[112:115], v[80:95]
    ds_read_b128 v[108:111], v10 offset:2400
    ds_read_b128 v[112:115], v11 offset:432
    ds_read_b128 v[116:119], v11 offset:2992
    ds_read_b128 v[120:123], v10 offset:352
    s_waitcnt lgkmcnt(10)
    v_mfma_f32_32x32x16_bf16 v[64:79], v[124:127], v[128:131], v[64:79]
    buffer_load_dwordx4 a[88:91], v2, s[48:51], s61 offen
    s_add_u32 s61, s61, 2048
    s_waitcnt lgkmcnt(9)
    v_mfma_f32_32x32x16_bf16 v[80:95], v[124:127], v[132:135], v[80:95]
    s_waitcnt lgkmcnt(8)
    v_mfma_f32_32x32x16_bf16 v[80:95], v[136:139], v[128:131], v[80:95]
    ds_read_b128 v[124:127], v10 offset:2304
    ds_read_b128 v[128:131], v11 offset:320
    ds_read_b128 v[132:135], v11 offset:2880
    ds_read_b128 v[136:139], v10 offset:256
    s_waitcnt lgkmcnt(10)
    v_mfma_f32_32x32x16_bf16 v[64:79], v[140:143], v[144:147], v[64:79]
    buffer_load_dwordx4 a[92:95], v2, s[48:51], s82 offen
    s_add_u32 s82, s82, 2048
    s_waitcnt lgkmcnt(9)
    v_mfma_f32_32x32x16_bf16 v[80:95], v[140:143], v[148:151], v[80:95]
    buffer_load_dwordx4 a[96:99], v2, s[48:51], s61 offen
    s_add_u32 s61, s61, 2048
    s_waitcnt lgkmcnt(8)
    v_mfma_f32_32x32x16_bf16 v[80:95], v[152:155], v[144:147], v[80:95]
    ds_read_b128 v[140:143], v10 offset:2336
    ds_read_b128 v[144:147], v11 offset:352
    ds_read_b128 v[148:151], v11 offset:2912
    ds_read_b128 v[152:155], v10 offset:288
    s_waitcnt lgkmcnt(10)
    v_mfma_f32_32x32x16_bf16 v[64:79], v[108:111], v[112:115], v[64:79]
    buffer_load_dwordx4 a[100:103], v2, s[48:51], s82 offen
    s_add_u32 s82, s82, 2048
    s_waitcnt lgkmcnt(9)
    v_mfma_f32_32x32x16_bf16 v[80:95], v[108:111], v[116:119], v[80:95]
    buffer_load_dwordx4 a[104:107], v2, s[48:51], s61 offen
    s_add_u32 s61, s61, 2048
    s_waitcnt lgkmcnt(8)
    v_mfma_f32_32x32x16_bf16 v[80:95], v[120:123], v[112:115], v[80:95]
    ds_read_b128 v[108:111], v10 offset:2240
    ds_read_b128 v[112:115], v11 offset:240
    ds_read_b128 v[116:119], v11 offset:2800
    ds_read_b128 v[120:123], v10 offset:192
    s_waitcnt lgkmcnt(10)
    v_mfma_f32_32x32x16_bf16 v[64:79], v[124:127], v[128:131], v[64:79]
    buffer_load_dwordx4 a[108:111], v2, s[48:51], s82 offen
    s_add_u32 s82, s82, 2048
    s_waitcnt lgkmcnt(9)
    v_mfma_f32_32x32x16_bf16 v[80:95], v[124:127], v[132:135], v[80:95]
    buffer_load_dwordx4 a[112:115], v2, s[48:51], s61 offen
    s_add_u32 s61, s61, 2048
    s_waitcnt lgkmcnt(8)
    v_mfma_f32_32x32x16_bf16 v[80:95], v[136:139], v[128:131], v[80:95]
    ds_read_b128 v[124:127], v10 offset:2272
    ds_read_b128 v[128:131], v11 offset:272
    ds_read_b128 v[132:135], v11 offset:2832
    ds_read_b128 v[136:139], v10 offset:224
    s_waitcnt lgkmcnt(10)
    v_mfma_f32_32x32x16_bf16 v[64:79], v[140:143], v[144:147], v[64:79]
    buffer_load_dwordx4 a[116:119], v2, s[48:51], s82 offen
    s_add_u32 s82, s82, 2048
    s_waitcnt lgkmcnt(9)
    v_mfma_f32_32x32x16_bf16 v[80:95], v[140:143], v[148:151], v[80:95]
    s_waitcnt lgkmcnt(8)
    v_mfma_f32_32x32x16_bf16 v[80:95], v[152:155], v[144:147], v[80:95]
    ds_read_b128 v[140:143], v10 offset:2176
    ds_read_b128 v[144:147], v11 offset:160
    ds_read_b128 v[148:151], v11 offset:2720
    ds_read_b128 v[152:155], v10 offset:128
    s_waitcnt lgkmcnt(10)
    v_mfma_f32_32x32x16_bf16 v[64:79], v[108:111], v[112:115], v[64:79]
    buffer_load_dwordx4 a[120:123], v2, s[48:51], s61 offen
    s_add_u32 s61, s61, 2048
    s_waitcnt lgkmcnt(9)
    v_mfma_f32_32x32x16_bf16 v[80:95], v[108:111], v[116:119], v[80:95]
    buffer_load_dwordx4 a[124:127], v2, s[48:51], s82 offen
    s_add_u32 s82, s82, 2048
    s_waitcnt lgkmcnt(8)
    v_mfma_f32_32x32x16_bf16 v[80:95], v[120:123], v[112:115], v[80:95]
    ds_read_b128 v[108:111], v10 offset:2208
    ds_read_b128 v[112:115], v11 offset:192
    ds_read_b128 v[116:119], v11 offset:2752
    ds_read_b128 v[120:123], v10 offset:160
    s_waitcnt lgkmcnt(10)
    v_mfma_f32_32x32x16_bf16 v[64:79], v[124:127], v[128:131], v[64:79]
    buffer_load_dwordx4 a[128:131], v2, s[48:51], s61 offen
    s_add_u32 s61, s61, 2048
    s_waitcnt lgkmcnt(9)
    v_mfma_f32_32x32x16_bf16 v[80:95], v[124:127], v[132:135], v[80:95]
    buffer_load_dwordx4 a[132:135], v2, s[48:51], s82 offen
    s_add_u32 s82, s82, 2048
    s_waitcnt lgkmcnt(8)
    v_mfma_f32_32x32x16_bf16 v[80:95], v[136:139], v[128:131], v[80:95]
    ds_read_b128 v[124:127], v10 offset:2112
    ds_read_b128 v[128:131], v11 offset:80
    ds_read_b128 v[132:135], v11 offset:2640
    ds_read_b128 v[136:139], v10 offset:64
    s_waitcnt lgkmcnt(10)
    v_mfma_f32_32x32x16_bf16 v[64:79], v[140:143], v[144:147], v[64:79]
    buffer_load_dwordx4 a[136:139], v2, s[48:51], s61 offen
    s_add_u32 s61, s61, 2048
    s_waitcnt lgkmcnt(9)
    v_mfma_f32_32x32x16_bf16 v[80:95], v[140:143], v[148:151], v[80:95]
    buffer_load_dwordx4 a[140:143], v2, s[48:51], s82 offen
    s_add_u32 s82, s82, 2048
    s_waitcnt lgkmcnt(8)
    v_mfma_f32_32x32x16_bf16 v[80:95], v[152:155], v[144:147], v[80:95]
    ds_read_b128 v[140:143], v10 offset:2144
    ds_read_b128 v[144:147], v11 offset:112
    ds_read_b128 v[148:151], v11 offset:2672
    ds_read_b128 v[152:155], v10 offset:96
    s_waitcnt lgkmcnt(10)
    v_mfma_f32_32x32x16_bf16 v[64:79], v[108:111], v[112:115], v[64:79]
    buffer_load_dwordx4 a[144:147], v2, s[48:51], s61 offen
    s_add_u32 s61, s61, 2048
    s_waitcnt lgkmcnt(9)
    v_mfma_f32_32x32x16_bf16 v[80:95], v[108:111], v[116:119], v[80:95]
    s_waitcnt lgkmcnt(8)
    v_mfma_f32_32x32x16_bf16 v[80:95], v[120:123], v[112:115], v[80:95]
    ds_read_b128 v[108:111], v10 offset:2048
    ds_read_b128 v[112:115], v11 offset:0
    ds_read_b128 v[116:119], v11 offset:2560
    ds_read_b128 v[120:123], v10 offset:0
    s_waitcnt lgkmcnt(10)
    v_mfma_f32_32x32x16_bf16 v[64:79], v[124:127], v[128:131], v[64:79]
    buffer_load_dwordx4 a[148:151], v2, s[48:51], s82 offen
    s_add_u32 s82, s82, 2048
    s_waitcnt lgkmcnt(9)
    v_mfma_f32_32x32x16_bf16 v[80:95], v[124:127], v[132:135], v[80:95]
    buffer_load_dwordx4 a[152:155], v2, s[48:51], s61 offen
    s_add_u32 s61, s61, 2048
    s_waitcnt lgkmcnt(8)
    v_mfma_f32_32x32x16_bf16 v[80:95], v[136:139], v[128:131], v[80:95]
    ds_read_b128 v[124:127], v10 offset:2080
    ds_read_b128 v[128:131], v11 offset:32
    ds_read_b128 v[132:135], v11 offset:2592
    ds_read_b128 v[136:139], v10 offset:32
    s_waitcnt lgkmcnt(10)
    v_mfma_f32_32x32x16_bf16 v[64:79], v[140:143], v[144:147], v[64:79]
    buffer_load_dwordx4 a[156:159], v2, s[48:51], s82 offen
    s_add_u32 s82, s82, 2048
    s_waitcnt lgkmcnt(9)
    v_mfma_f32_32x32x16_bf16 v[80:95], v[140:143], v[148:151], v[80:95]
    buffer_load_dwordx4 a[160:163], v2, s[48:51], s61 offen
    s_add_u32 s61, s61, 2048
    s_waitcnt lgkmcnt(8)
    v_mfma_f32_32x32x16_bf16 v[80:95], v[152:155], v[144:147], v[80:95]
    s_waitcnt lgkmcnt(6)
    v_mfma_f32_32x32x16_bf16 v[64:79], v[108:111], v[112:115], v[64:79]
    buffer_load_dwordx4 a[164:167], v2, s[48:51], s82 offen
    s_add_u32 s82, s82, 2048
    s_waitcnt lgkmcnt(5)
    v_mfma_f32_32x32x16_bf16 v[80:95], v[108:111], v[116:119], v[80:95]
    buffer_load_dwordx4 a[168:171], v2, s[48:51], s61 offen
    s_add_u32 s61, s61, 2048
    s_waitcnt lgkmcnt(4)
    v_mfma_f32_32x32x16_bf16 v[80:95], v[120:123], v[112:115], v[80:95]
    s_waitcnt lgkmcnt(2)
    v_mfma_f32_32x32x16_bf16 v[64:79], v[124:127], v[128:131], v[64:79]
    buffer_load_dwordx4 a[172:175], v2, s[48:51], s82 offen
    s_add_u32 s82, s82, 2048
    s_waitcnt lgkmcnt(1)
    v_mfma_f32_32x32x16_bf16 v[80:95], v[124:127], v[132:135], v[80:95]
    s_waitcnt lgkmcnt(0)
    v_mfma_f32_32x32x16_bf16 v[80:95], v[136:139], v[128:131], v[80:95]
    buffer_load_dwordx4 a[176:179], v2, s[48:51], s61 offen
    s_add_u32 s61, s61, 2048
    buffer_load_dwordx4 a[180:183], v2, s[48:51], s82 offen
    s_add_u32 s82, s82, 2048
    buffer_load_dwordx4 a[184:187], v2, s[48:51], s61 offen
    s_add_u32 s61, s61, 2048
    buffer_load_dwordx4 a[188:191], v2, s[48:51], s82 offen
    s_add_u32 s82, s82, 2048
    buffer_load_dwordx4 a[192:195], v2, s[48:51], s61 offen
    s_add_u32 s61, s61, 2048
    buffer_load_dwordx4 a[196:199], v2, s[48:51], s82 offen
    s_add_u32 s82, s82, 2048

    s_lshl_b32 s59, s33, 12
    s_add_u32 s59, s59, 81920
    v_add_u32 v16, s59, v2
    s_xor_b32 s60, s33, 1
    s_lshl_b32 s60, s60, 12
    s_add_u32 s60, s60, 81920
    v_add_u32 v17, s60, v2
    v_lshlrev_b32 v18, 5, v8
    v_lshlrev_b32 v19, 2, v9
    v_add_u32 v18, v18, v19
    s_lshl_b32 s60, s35, 10
    v_add_u32 v18, s60, v18
    v_lshlrev_b32 v19, 1, v18
    s_mul_i32 s60, s34, 33280
    s_add_u32 s60, s60, 4040
    v_sub_u32 v19, s60, v19
    ds_read_b64 v[20:21], v19 offset:48
    ds_read_b64 v[22:23], v19 offset:32
    ds_read_b64 v[24:25], v19 offset:16
    ds_read_b64 v[26:27], v19 offset:0
    s_cmp_eq_u32 s35, 0
    s_cbranch_scc1 fz_h0
    ds_write_b128 v16, v[64:67] offset:0
    ds_write_b128 v16, v[68:71] offset:1024
    ds_write_b128 v16, v[72:75] offset:2048
    ds_write_b128 v16, v[76:79] offset:3072
    v_pk_mul_f32 v[48:49], v[80:81], 1.0 op_sel_hi:[1,0]
    v_pk_mul_f32 v[50:51], v[82:83], 1.0 op_sel_hi:[1,0]
    v_pk_mul_f32 v[52:53], v[84:85], 1.0 op_sel_hi:[1,0]
    v_pk_mul_f32 v[54:55], v[86:87], 1.0 op_sel_hi:[1,0]
    v_pk_mul_f32 v[56:57], v[88:89], 1.0 op_sel_hi:[1,0]
    v_pk_mul_f32 v[58:59], v[90:91], 1.0 op_sel_hi:[1,0]
    v_pk_mul_f32 v[60:61], v[92:93], 1.0 op_sel_hi:[1,0]
    v_pk_mul_f32 v[62:63], v[94:95], 1.0 op_sel_hi:[1,0]
    s_branch fz_x
fz_h0:
    s_nop 7
    ds_write_b128 v16, v[80:83] offset:0
    ds_write_b128 v16, v[84:87] offset:1024
    ds_write_b128 v16, v[88:91] offset:2048
    ds_write_b128 v16, v[92:95] offset:3072
    v_pk_mul_f32 v[48:49], v[64:65], 1.0 op_sel_hi:[1,0]
    v_pk_mul_f32 v[50:51], v[66:67], 1.0 op_sel_hi:[1,0]
    v_pk_mul_f32 v[52:53], v[68:69], 1.0 op_sel_hi:[1,0]
    v_pk_mul_f32 v[54:55], v[70:71], 1.0 op_sel_hi:[1,0]
    v_pk_mul_f32 v[56:57], v[72:73], 1.0 op_sel_hi:[1,0]
    v_pk_mul_f32 v[58:59], v[74:75], 1.0 op_sel_hi:[1,0]
    v_pk_mul_f32 v[60:61], v[76:77], 1.0 op_sel_hi:[1,0]
    v_pk_mul_f32 v[62:63], v[78:79], 1.0 op_sel_hi:[1,0]
fz_x:
    s_and_b32 s59, s52, 1
    s_lshl_b32 s59, s59, 4
    s_lshr_b32 s55, s55, s59
    s_lshl_b32 s55, s55, 16
    s_waitcnt lgkmcnt(0)
    s_barrier
    ds_read_b128 v[32:35], v17 offset:0
    ds_read_b128 v[36:39], v17 offset:1024
    ds_read_b128 v[40:43], v17 offset:2048
    ds_read_b128 v[44:47], v17 offset:3072
    buffer_load_dwordx4 a[200:203], v2, s[48:51], s61 offen
    s_add_u32 s61, s61, 2048
    buffer_load_dwordx4 a[204:207], v2, s[48:51], s82 offen
    s_add_u32 s82, s82, 2048
    buffer_load_dwordx4 a[208:211], v2, s[48:51], s61 offen
    s_add_u32 s61, s61, 2048
    buffer_load_dwordx4 a[212:215], v2, s[48:51], s82 offen
    s_add_u32 s82, s82, 2048
    buffer_load_dwordx4 a[216:219], v2, s[48:51], s61 offen
    s_add_u32 s61, s61, 2048
    buffer_load_dwordx4 a[220:223], v2, s[48:51], s82 offen
    s_add_u32 s82, s82, 2048
    v_and_b32 v108, 0xffff0000, v21
    v_lshlrev_b32 v109, 16, v21
    v_and_b32 v110, 0xffff0000, v20
    v_lshlrev_b32 v111, 16, v20
    v_and_b32 v112, 0xffff0000, v23
    v_lshlrev_b32 v113, 16, v23
    v_and_b32 v114, 0xffff0000, v22
    v_lshlrev_b32 v115, 16, v22
    v_and_b32 v116, 0xffff0000, v25
    v_lshlrev_b32 v117, 16, v25
    v_and_b32 v118, 0xffff0000, v24
    v_lshlrev_b32 v119, 16, v24
    v_and_b32 v120, 0xffff0000, v27
    v_lshlrev_b32 v121, 16, v27
    v_and_b32 v122, 0xffff0000, v26
    v_lshlrev_b32 v123, 16, v26
    v_fmac_f32 v48, s55, v108
    v_fmac_f32 v49, s55, v109
    v_fmac_f32 v50, s55, v110
    v_fmac_f32 v51, s55, v111
    v_fmac_f32 v52, s55, v112
    v_fmac_f32 v53, s55, v113
    v_fmac_f32 v54, s55, v114
    v_fmac_f32 v55, s55, v115
    v_fmac_f32 v56, s55, v116
    v_fmac_f32 v57, s55, v117
    v_fmac_f32 v58, s55, v118
    v_fmac_f32 v59, s55, v119
    v_fmac_f32 v60, s55, v120
    v_fmac_f32 v61, s55, v121
    v_fmac_f32 v62, s55, v122
    v_fmac_f32 v63, s55, v123
    s_waitcnt lgkmcnt(0)
    v_pk_add_f32 v[48:49], v[48:49], v[32:33]
    v_pk_add_f32 v[50:51], v[50:51], v[34:35]
    v_pk_add_f32 v[52:53], v[52:53], v[36:37]
    v_pk_add_f32 v[54:55], v[54:55], v[38:39]
    v_pk_add_f32 v[56:57], v[56:57], v[40:41]
    v_pk_add_f32 v[58:59], v[58:59], v[42:43]
    v_pk_add_f32 v[60:61], v[60:61], v[44:45]
    v_pk_add_f32 v[62:63], v[62:63], v[46:47]
    v_cvt_pk_bf16_f32 v20, v48, v49
    v_cvt_pk_bf16_f32 v21, v50, v51
    v_cvt_pk_bf16_f32 v22, v52, v53
    v_cvt_pk_bf16_f32 v23, v54, v55
    v_cvt_pk_bf16_f32 v24, v56, v57
    v_cvt_pk_bf16_f32 v25, v58, v59
    v_cvt_pk_bf16_f32 v26, v60, v61
    v_cvt_pk_bf16_f32 v27, v62, v63
    v_mul_u32_u24 v28, 144, v8
    v_lshlrev_b32 v29, 3, v9
    v_add_u32 v28, v28, v29
    s_mul_i32 s60, s35, 4608
    s_lshl_b32 s59, s34, 6
    s_add_u32 s60, s60, s59
    s_add_u32 s60, s60, 8448
    v_add_u32 v28, s60, v28
    ds_write_b64 v28, v[20:21] offset:0
    ds_write_b64 v28, v[22:23] offset:16
    ds_write_b64 v28, v[24:25] offset:32
    ds_write_b64 v28, v[26:27] offset:48
    v_lshrrev_b32 v29, 3, v1
    v_mul_u32_u24 v29, 144, v29
    v_and_b32 v30, 7, v1
    v_lshlrev_b32 v30, 4, v30
    v_add_u32 v29, v29, v30
    s_mul_i32 s60, s35, 4608
    s_mul_i32 s59, s34, 2304
    s_add_u32 s60, s60, s59
    s_add_u32 s60, s60, 8448
    v_add_u32 v29, s60, v29
    s_lshl_b32 s56, s2, 13
    s_lshl_b32 s60, s35, 12
    s_add_u32 s56, s56, s60
    s_lshl_b32 s60, s34, 11
    s_add_u32 s56, s56, s60
    s_waitcnt lgkmcnt(0)
    s_barrier
    ds_read_b128 v[32:35], v29
    ds_read_b128 v[36:39], v29 offset:1152
    s_waitcnt lgkmcnt(0)
    buffer_store_dwordx4 v[32:35], v2, s[44:47], s56 offen sc1
    buffer_store_dwordx4 v[36:39], v2, s[44:47], s56 offen offset:1024 sc1
    s_waitcnt vmcnt(2)
    v_lshlrev_b32 v32, 16, v160
    v_and_b32 v33, 0xffff0000, v160
    v_lshlrev_b32 v34, 16, v161
    v_and_b32 v35, 0xffff0000, v161
    v_lshlrev_b32 v36, 16, v162
    v_and_b32 v37, 0xffff0000, v162
    v_lshlrev_b32 v38, 16, v163
    v_and_b32 v39, 0xffff0000, v163
    v_lshlrev_b32 v40, 16, v164
    v_and_b32 v41, 0xffff0000, v164
    v_lshlrev_b32 v42, 16, v165
    v_and_b32 v43, 0xffff0000, v165
    v_lshlrev_b32 v44, 16, v166
    v_and_b32 v45, 0xffff0000, v166
    v_lshlrev_b32 v46, 16, v167
    v_and_b32 v47, 0xffff0000, v167
    v_readfirstlane_b32 s52, v32
    v_readfirstlane_b32 s54, v40
    s_nop 0
    v_pk_add_f32 v[48:49], v[32:33], s[52:53] op_sel_hi:[1,0] neg_lo:[0,1] neg_hi:[0,1]
    v_pk_add_f32 v[50:51], v[34:35], s[52:53] op_sel_hi:[1,0] neg_lo:[0,1] neg_hi:[0,1]
    v_pk_add_f32 v[52:53], v[36:37], s[52:53] op_sel_hi:[1,0] neg_lo:[0,1] neg_hi:[0,1]
    v_pk_add_f32 v[54:55], v[38:39], s[52:53] op_sel_hi:[1,0] neg_lo:[0,1] neg_hi:[0,1]
    v_pk_add_f32 v[56:57], v[40:41], s[54:55] op_sel_hi:[1,0] neg_lo:[0,1] neg_hi:[0,1]
    v_pk_add_f32 v[58:59], v[42:43], s[54:55] op_sel_hi:[1,0] neg_lo:[0,1] neg_hi:[0,1]
    v_pk_add_f32 v[60:61], v[44:45], s[54:55] op_sel_hi:[1,0] neg_lo:[0,1] neg_hi:[0,1]
    v_pk_add_f32 v[62:63], v[46:47], s[54:55] op_sel_hi:[1,0] neg_lo:[0,1] neg_hi:[0,1]
    v_pk_add_f32 v[16:17], v[48:49], v[50:51]
    v_pk_mul_f32 v[18:19], v[48:49], v[48:49]
    v_pk_add_f32 v[20:21], v[56:57], v[58:59]
    v_pk_mul_f32 v[22:23], v[56:57], v[56:57]
    v_pk_add_f32 v[16:17], v[16:17], v[52:53]
    v_pk_fma_f32 v[18:19], v[50:51], v[50:51], v[18:19]
    v_pk_add_f32 v[20:21], v[20:21], v[60:61]
    v_pk_fma_f32 v[22:23], v[58:59], v[58:59], v[22:23]
    v_pk_add_f32 v[16:17], v[16:17], v[54:55]
    v_pk_fma_f32 v[18:19], v[52:53], v[52:53], v[18:19]
    v_pk_add_f32 v[20:21], v[20:21], v[62:63]
    v_pk_fma_f32 v[22:23], v[60:61], v[60:61], v[22:23]
    v_pk_fma_f32 v[18:19], v[54:55], v[54:55], v[18:19]
    v_add_f32 v16, v16, v17
    v_pk_fma_f32 v[22:23], v[62:63], v[62:63], v[22:23]
    v_add_f32 v20, v20, v21
    v_add_f32 v18, v18, v19
    v_add_f32 v22, v22, v23
    v_add_f32_dpp v16, v16, v16 row_shr:1 row_mask:0xf bank_mask:0xf
    v_add_f32_dpp v18, v18, v18 row_shr:1 row_mask:0xf bank_mask:0xf
    v_add_f32_dpp v20, v20, v20 row_shr:1 row_mask:0xf bank_mask:0xf
    v_add_f32_dpp v22, v22, v22 row_shr:1 row_mask:0xf bank_mask:0xf
    v_add_f32_dpp v16, v16, v16 row_shr:2 row_mask:0xf bank_mask:0xf
    v_add_f32_dpp v18, v18, v18 row_shr:2 row_mask:0xf bank_mask:0xf
    v_add_f32_dpp v20, v20, v20 row_shr:2 row_mask:0xf bank_mask:0xf
    v_add_f32_dpp v22, v22, v22 row_shr:2 row_mask:0xf bank_mask:0xf
    v_add_f32_dpp v16, v16, v16 row_shr:4 row_mask:0xf bank_mask:0xf
    v_add_f32_dpp v18, v18, v18 row_shr:4 row_mask:0xf bank_mask:0xf
    v_add_f32_dpp v20, v20, v20 row_shr:4 row_mask:0xf bank_mask:0xf
    v_add_f32_dpp v22, v22, v22 row_shr:4 row_mask:0xf bank_mask:0xf
    v_add_f32_dpp v16, v16, v16 row_shr:8 row_mask:0xf bank_mask:0xf
    v_add_f32_dpp v18, v18, v18 row_shr:8 row_mask:0xf bank_mask:0xf
    v_add_f32_dpp v20, v20, v20 row_shr:8 row_mask:0xf bank_mask:0xf
    v_add_f32_dpp v22, v22, v22 row_shr:8 row_mask:0xf bank_mask:0xf
    v_add_f32_dpp v16, v16, v16 row_bcast:15 row_mask:0xa bank_mask:0xf
    v_add_f32_dpp v18, v18, v18 row_bcast:15 row_mask:0xa bank_mask:0xf
    v_add_f32_dpp v20, v20, v20 row_bcast:15 row_mask:0xa bank_mask:0xf
    v_add_f32_dpp v22, v22, v22 row_bcast:15 row_mask:0xa bank_mask:0xf
    v_add_f32_dpp v16, v16, v16 row_bcast:31 row_mask:0xc bank_mask:0xf
    v_add_f32_dpp v18, v18, v18 row_bcast:31 row_mask:0xc bank_mask:0xf
    v_add_f32_dpp v20, v20, v20 row_bcast:31 row_mask:0xc bank_mask:0xf
    v_add_f32_dpp v22, v22, v22 row_bcast:31 row_mask:0xc bank_mask:0xf
    v_readlane_b32 s56, v16, 63
    v_readlane_b32 s57, v18, 63
    v_readlane_b32 s58, v20, 63
    v_readlane_b32 s59, v22, 63
    v_mov_b32 v16, s56
    v_mov_b32 v18, s57
    v_mov_b32 v20, s58
    v_mov_b32 v22, s59
    v_mul_f32 v16, 0x3b000000, v16
    v_mul_f32 v18, 0x3b000000, v18
    v_mul_f32 v20, 0x3b000000, v20
    v_mul_f32 v22, 0x3b000000, v22
    v_fma_f32 v18, -v16, v16, v18
    v_fma_f32 v22, -v20, v20, v22
    v_max_f32 v18, 0, v18
    v_max_f32 v22, 0, v22
    v_add_f32 v18, 0x3727c5ac, v18
    v_add_f32 v22, 0x3727c5ac, v22
    v_rsq_f32 v18, v18
    v_rsq_f32 v22, v22
    v_mul_f32 v16, v16, v18
    v_mul_f32 v20, v20, v22
    v_pk_fma_f32 v[48:49], v[48:49], v[18:19], v[16:17] op_sel_hi:[1,0,0] neg_lo:[0,0,1] neg_hi:[0,0,1]
    v_pk_fma_f32 v[50:51], v[50:51], v[18:19], v[16:17] op_sel_hi:[1,0,0] neg_lo:[0,0,1] neg_hi:[0,0,1]
    v_pk_fma_f32 v[52:53], v[52:53], v[18:19], v[16:17] op_sel_hi:[1,0,0] neg_lo:[0,0,1] neg_hi:[0,0,1]
    v_pk_fma_f32 v[54:55], v[54:55], v[18:19], v[16:17] op_sel_hi:[1,0,0] neg_lo:[0,0,1] neg_hi:[0,0,1]
    v_pk_fma_f32 v[56:57], v[56:57], v[22:23], v[20:21] op_sel_hi:[1,0,0] neg_lo:[0,0,1] neg_hi:[0,0,1]
    v_pk_fma_f32 v[58:59], v[58:59], v[22:23], v[20:21] op_sel_hi:[1,0,0] neg_lo:[0,0,1] neg_hi:[0,0,1]
    v_pk_fma_f32 v[60:61], v[60:61], v[22:23], v[20:21] op_sel_hi:[1,0,0] neg_lo:[0,0,1] neg_hi:[0,0,1]
    v_pk_fma_f32 v[62:63], v[62:63], v[22:23], v[20:21] op_sel_hi:[1,0,0] neg_lo:[0,0,1] neg_hi:[0,0,1]
    s_waitcnt vmcnt(0)
    s_barrier
    s_cmp_lg_u32 s33, 0
    s_cbranch_scc1 g1b_pf
    s_lshl_b32 s34, s62, 7
    s_lshl_b32 s35, s63, 2
    s_add_u32 s35, s35, s34
    v_mov_b32 v6, 2
    v_mov_b32 v7, 0
    s_mov_b64 exec, 1
    buffer_store_dword v6, v7, s[72:75], s35 offen
    s_mov_b64 exec, -1
    s_mov_b32 s69, 0
    s_cmp_lg_u32 s63, 0
    s_cbranch_scc1 g1b_nl
    v_and_b32 v16, 31, v1
    v_lshlrev_b32 v16, 2, v16
g1b_p1:
    buffer_load_dword v17, v16, s[72:75], s34 offen sc1
    s_add_u32 s69, s69, 1
    s_cmp_gt_u32 s69, 200000
    s_cbranch_scc1 g1b_w
    s_waitcnt vmcnt(0)
    v_cmp_gt_u32 vcc, 2, v17
    s_nop 0
    s_cmp_lg_u64 vcc, 0
    s_cbranch_scc1 g1b_p1

    v_and_b32 v16, 7, v1
    v_lshlrev_b32 v16, 7, v16
    s_lshl_b32 s35, s62, 2
    s_add_u32 s35, s35, 1024
    s_mov_b64 exec, 0xff
    buffer_store_dword v6, v16, s[72:75], s35 offen sc1
    s_mov_b64 exec, -1
g1b_nl:
    v_and_b32 v16, 7, v1
    v_lshlrev_b32 v16, 2, v16
    s_add_u32 s35, s34, 1024
g1b_p2:
    buffer_load_dword v17, v16, s[72:75], s35 offen sc1
    s_add_u32 s69, s69, 1
    s_cmp_gt_u32 s69, 200000
    s_cbranch_scc1 g1b_w
    s_waitcnt vmcnt(0)
    v_cmp_gt_u32 vcc, 2, v17
    s_nop 0
    s_cmp_lg_u64 vcc, 0
    s_cbranch_scc1 g1b_p2
    s_branch g1b_w
g1b_pf:
    s_cmp_lg_u32 s33, 1
    s_cbranch_scc1 wb_dma
    s_branch wb_tr
wb_dma:
    s_mov_b32 s92, s20
    s_mov_b32 s93, s21
    s_mov_b32 s94, 0x1c0000
    s_mov_b32 s95, 0x20000
    s_mov_b32 s40, s18
    s_mov_b32 s41, s19
    s_mov_b32 s42, 0x1c0000
    s_mov_b32 s43, 0x20000
    s_cmp_eq_u32 s33, 3
    s_cselect_b32 s40, s92, s40
    s_cselect_b32 s41, s93, s41
    s_cselect_b32 s56, 15232, 0
    s_mul_i32 s54, s31, 224
    s_mov_b32 s55, 4682
    v_mul_lo_u32 v6, v1, s55
    v_lshrrev_b32 v6, 16, v6
    v_mul_u32_u24 v16, 14, v6
    v_sub_u32 v16, v1, v16
    v_mul_u32_u24 v6, 3584, v6
    v_lshlrev_b32 v16, 4, v16
    v_add_u32 v6, v6, v16
    s_mov_b32 s57, 13440
    s_cselect_b32 s57, 14336, s57
    s_mov_b32 exec_hi, 0x00ffffff
    s_add_u32 m0, s56, 0
    s_nop 0
    buffer_load_dwordx4 v6, s[40:43], s54 offen lds
    s_add_u32 s54, s54, 14336
    s_add_u32 m0, s56, 896
    s_nop 0
    buffer_load_dwordx4 v6, s[40:43], s54 offen lds
    s_add_u32 s54, s54, 14336
    s_add_u32 m0, s56, 1792
    s_nop 0
    buffer_load_dwordx4 v6, s[40:43], s54 offen lds
    s_add_u32 s54, s54, 14336
    s_add_u32 m0, s56, 2688
    s_nop 0
    buffer_load_dwordx4 v6, s[40:43], s54 offen lds
    s_add_u32 s54, s54, 14336
    s_add_u32 m0, s56, 3584
    s_nop 0
    buffer_load_dwordx4 v6, s[40:43], s54 offen lds
    s_add_u32 s54, s54, 14336
    s_add_u32 m0, s56, 4480
    s_nop 0
    buffer_load_dwordx4 v6, s[40:43], s54 offen lds
    s_add_u32 s54, s54, 14336
    s_add_u32 m0, s56, 5376
    s_nop 0
    buffer_load_dwordx4 v6, s[40:43], s54 offen lds
    s_add_u32 s54, s54, 14336
    s_add_u32 m0, s56, 6272
    s_nop 0
    buffer_load_dwordx4 v6, s[40:43], s54 offen lds
    s_add_u32 s54, s54, 14336
    s_add_u32 m0, s56, 7168
    s_nop 0
    buffer_load_dwordx4 v6, s[40:43], s54 offen lds
    s_add_u32 s54, s54, 14336
    s_add_u32 m0, s56, 8064
    s_nop 0
    buffer_load_dwordx4 v6, s[40:43], s54 offen lds
    s_add_u32 s54, s54, 14336
    s_add_u32 m0, s56, 8960
    s_nop 0
    buffer_load_dwordx4 v6, s[40:43], s54 offen lds
    s_add_u32 s54, s54, 14336
    s_add_u32 m0, s56, 9856
    s_nop 0
    buffer_load_dwordx4 v6, s[40:43], s54 offen lds
    s_add_u32 s54, s54, 14336
    s_add_u32 m0, s56, 10752
    s_nop 0
    buffer_load_dwordx4 v6, s[40:43], s54 offen lds
    s_add_u32 s54, s54, 14336
    s_add_u32 m0, s56, 11648
    s_nop 0
    buffer_load_dwordx4 v6, s[40:43], s54 offen lds
    s_add_u32 s54, s54, 14336
    s_add_u32 m0, s56, 12544
    s_nop 0
    buffer_load_dwordx4 v6, s[40:43], s54 offen lds
    s_add_u32 s54, s54, 14336
    s_add_u32 m0, s57, 0
    s_nop 0
    buffer_load_dwordx4 v6, s[40:43], s54 offen lds
    s_add_u32 s54, s54, 14336
    s_add_u32 m0, s56, 28672
    s_nop 0
    buffer_load_dwordx4 v6, s[40:43], s54 offen lds
    s_add_u32 s54, s54, 14336
    s_add_u32 m0, s56, 29568
    s_nop 0
    buffer_load_dwordx4 v6, s[40:43], s54 offen lds
    s_add_u32 s54, s54, 14336
    s_add_u32 m0, s56, 30464
    s_nop 0
    buffer_load_dwordx4 v6, s[40:43], s54 offen lds
    s_add_u32 s54, s54, 14336
    s_add_u32 m0, s56, 31360
    s_nop 0
    buffer_load_dwordx4 v6, s[40:43], s54 offen lds
    s_add_u32 s54, s54, 14336
    s_add_u32 m0, s56, 32256
    s_nop 0
    buffer_load_dwordx4 v6, s[40:43], s54 offen lds
    s_add_u32 s54, s54, 14336
    s_add_u32 m0, s56, 33152
    s_nop 0
    buffer_load_dwordx4 v6, s[40:43], s54 offen lds
    s_add_u32 s54, s54, 14336
    s_add_u32 m0, s56, 34048
    s_nop 0
    buffer_load_dwordx4 v6, s[40:43], s54 offen lds
    s_add_u32 s54, s54, 14336
    s_add_u32 m0, s56, 34944
    s_nop 0
    buffer_load_dwordx4 v6, s[40:43], s54 offen lds
    s_add_u32 s54, s54, 14336
    s_add_u32 m0, s56, 35840
    s_nop 0
    buffer_load_dwordx4 v6, s[40:43], s54 offen lds
    s_add_u32 s54, s54, 14336
    s_add_u32 m0, s56, 36736
    s_nop 0
    buffer_load_dwordx4 v6, s[40:43], s54 offen lds
    s_add_u32 s54, s54, 14336
    s_add_u32 m0, s56, 37632
    s_nop 0
    buffer_load_dwordx4 v6, s[40:43], s54 offen lds
    s_add_u32 s54, s54, 14336
    s_add_u32 m0, s56, 38528
    s_nop 0
    buffer_load_dwordx4 v6, s[40:43], s54 offen lds
    s_add_u32 s54, s54, 14336
    s_add_u32 m0, s56, 39424
    s_nop 0
    buffer_load_dwordx4 v6, s[40:43], s54 offen lds
    s_add_u32 s54, s54, 14336
    s_add_u32 m0, s56, 40320
    s_nop 0
    buffer_load_dwordx4 v6, s[40:43], s54 offen lds
    s_add_u32 s54, s54, 14336
    s_add_u32 m0, s56, 41216
    s_nop 0
    buffer_load_dwordx4 v6, s[40:43], s54 offen lds
    s_add_u32 s54, s54, 14336
    s_add_u32 m0, s57, 28672
    s_nop 0
    buffer_load_dwordx4 v6, s[40:43], s54 offen lds
    s_add_u32 s54, s54, 14336
    s_add_u32 m0, s56, 57344
    s_nop 0
    buffer_load_dwordx4 v6, s[40:43], s54 offen lds
    s_add_u32 s54, s54, 14336
    s_add_u32 m0, s56, 58240
    s_nop 0
    buffer_load_dwordx4 v6, s[40:43], s54 offen lds
    s_add_u32 s54, s54, 14336
    s_add_u32 m0, s56, 59136
    s_nop 0
    buffer_load_dwordx4 v6, s[40:43], s54 offen lds
    s_add_u32 s54, s54, 14336
    s_add_u32 m0, s56, 60032
    s_nop 0
    buffer_load_dwordx4 v6, s[40:43], s54 offen lds
    s_add_u32 s54, s54, 14336
    s_add_u32 m0, s56, 60928
    s_nop 0
    buffer_load_dwordx4 v6, s[40:43], s54 offen lds
    s_add_u32 s54, s54, 14336
    s_add_u32 m0, s56, 61824
    s_nop 0
    buffer_load_dwordx4 v6, s[40:43], s54 offen lds
    s_add_u32 s54, s54, 14336
    s_add_u32 m0, s56, 62720
    s_nop 0
    buffer_load_dwordx4 v6, s[40:43], s54 offen lds
    s_add_u32 s54, s54, 14336
    s_add_u32 m0, s56, 63616
    s_nop 0
    buffer_load_dwordx4 v6, s[40:43], s54 offen lds
    s_add_u32 s54, s54, 14336
    s_add_u32 m0, s56, 64512
    s_nop 0
    buffer_load_dwordx4 v6, s[40:43], s54 offen lds
    s_add_u32 s54, s54, 14336
    s_add_u32 m0, s56, 65408
    s_nop 0
    buffer_load_dwordx4 v6, s[40:43], s54 offen lds
    s_add_u32 s54, s54, 14336
    s_add_u32 m0, s56, 66304
    s_nop 0
    buffer_load_dwordx4 v6, s[40:43], s54 offen lds
    s_add_u32 s54, s54, 14336
    s_add_u32 m0, s56, 67200
    s_nop 0
    buffer_load_dwordx4 v6, s[40:43], s54 offen lds
    s_add_u32 s54, s54, 14336
    s_add_u32 m0, s56, 68096
    s_nop 0
    buffer_load_dwordx4 v6, s[40:43], s54 offen lds
    s_add_u32 s54, s54, 14336
    s_add_u32 m0, s56, 68992
    s_nop 0
    buffer_load_dwordx4 v6, s[40:43], s54 offen lds
    s_add_u32 s54, s54, 14336
    s_add_u32 m0, s56, 69888
    s_nop 0
    buffer_load_dwordx4 v6, s[40:43], s54 offen lds
    s_add_u32 s54, s54, 14336
    s_add_u32 m0, s57, 57344
    s_nop 0
    buffer_load_dwordx4 v6, s[40:43], s54 offen lds
    s_add_u32 s54, s54, 14336
    s_add_u32 m0, s56, 86016
    s_nop 0
    buffer_load_dwordx4 v6, s[40:43], s54 offen lds
    s_add_u32 s54, s54, 14336
    s_add_u32 m0, s56, 86912
    s_nop 0
    buffer_load_dwordx4 v6, s[40:43], s54 offen lds
    s_add_u32 s54, s54, 14336
    s_add_u32 m0, s56, 87808
    s_nop 0
    buffer_load_dwordx4 v6, s[40:43], s54 offen lds
    s_add_u32 s54, s54, 14336
    s_add_u32 m0, s56, 88704
    s_nop 0
    buffer_load_dwordx4 v6, s[40:43], s54 offen lds
    s_add_u32 s54, s54, 14336
    s_add_u32 m0, s56, 89600
    s_nop 0
    buffer_load_dwordx4 v6, s[40:43], s54 offen lds
    s_add_u32 s54, s54, 14336
    s_add_u32 m0, s56, 90496
    s_nop 0
    buffer_load_dwordx4 v6, s[40:43], s54 offen lds
    s_add_u32 s54, s54, 14336
    s_add_u32 m0, s56, 91392
    s_nop 0
    buffer_load_dwordx4 v6, s[40:43], s54 offen lds
    s_add_u32 s54, s54, 14336
    s_add_u32 m0, s56, 92288
    s_nop 0
    buffer_load_dwordx4 v6, s[40:43], s54 offen lds
    s_add_u32 s54, s54, 14336
    s_add_u32 m0, s56, 93184
    s_nop 0
    buffer_load_dwordx4 v6, s[40:43], s54 offen lds
    s_add_u32 s54, s54, 14336
    s_add_u32 m0, s56, 94080
    s_nop 0
    buffer_load_dwordx4 v6, s[40:43], s54 offen lds
    s_add_u32 s54, s54, 14336
    s_add_u32 m0, s56, 94976
    s_nop 0
    buffer_load_dwordx4 v6, s[40:43], s54 offen lds
    s_add_u32 s54, s54, 14336
    s_add_u32 m0, s56, 95872
    s_nop 0
    buffer_load_dwordx4 v6, s[40:43], s54 offen lds
    s_add_u32 s54, s54, 14336
    s_add_u32 m0, s56, 96768
    s_nop 0
    buffer_load_dwordx4 v6, s[40:43], s54 offen lds
    s_add_u32 s54, s54, 14336
    s_add_u32 m0, s56, 97664
    s_nop 0
    buffer_load_dwordx4 v6, s[40:43], s54 offen lds
    s_add_u32 s54, s54, 14336
    s_add_u32 m0, s56, 98560
    s_nop 0
    buffer_load_dwordx4 v6, s[40:43], s54 offen lds
    s_add_u32 s54, s54, 14336
    s_add_u32 m0, s57, 86016
    s_nop 0
    buffer_load_dwordx4 v6, s[40:43], s54 offen lds
    s_add_u32 s54, s54, 14336
    s_mov_b32 exec_hi, -1
wb_tr:
g1b_w:
    s_barrier
    v_mov_b32 v7, 0
    s_mov_b32 s88, s28
    s_mov_b32 s89, s29
    s_mov_b32 s90, 0x3000000
    s_mov_b32 s91, 0x20000
    s_mov_b32 s36, s4
    s_mov_b32 s37, s5
    s_mov_b32 s38, 0x200000
    s_mov_b32 s39, 0x20000
    s_add_u32 s40, s28, 0x408000
    s_addc_u32 s41, s29, 0
    s_mov_b32 s42, 0x200000
    s_mov_b32 s43, 0x20000
    s_mov_b32 s44, s24
    s_mov_b32 s45, s25
    s_mov_b32 s46, 0x200000
    s_mov_b32 s47, 0x20000
    s_add_u32 s48, s28, 0x1000000
    s_addc_u32 s49, s29, 0
    s_mov_b32 s50, 0x200000
    s_mov_b32 s51, 0x20000
    s_add_u32 s52, s28, 0x1a00000
    s_addc_u32 s53, s29, 0
    s_mov_b32 s54, 0x200000
    s_mov_b32 s55, 0x20000

    s_lshl_b32 s34, s30, 7
    s_lshl_b32 s35, s31, 3
    s_add_u32 s32, s34, s35
    s_lshl_b32 s34, s33, 1
    s_add_u32 s34, s34, s32
    s_lshl_b32 s35, s34, 10
    v_lshlrev_b32 v24, 13, v0
    s_lshr_b32 s56, s32, 5
    s_lshl_b32 s56, s56, 7
    s_and_b32 s57, s32, 31
    s_lshl_b32 s57, s57, 1
    s_add_u32 s56, s56, s57
    buffer_load_dwordx4 v[16:19], v24, s[40:43], s56 offen
    buffer_load_dwordx4 v[20:23], v24, s[40:43], s56 offen offset:64
    s_mov_b32 s57, 0x05040100
    s_mov_b32 s58, 0x07060302
    v_lshlrev_b32 v25, 2, v0
    v_add_u32 v25, 143360, v25
    s_lshl_b32 s94, s30, 7
    s_lshl_b32 s95, s31, 3
    s_add_u32 s94, s94, s95
    s_lshl_b32 s95, s94, 10
    s_add_u32 s97, s95, 0x1400000
    s_lshr_b32 s96, s94, 5
    s_lshl_b32 s96, s96, 15
    s_and_b32 s94, s94, 31
    s_lshl_b32 s94, s94, 4
    s_add_u32 s96, s96, s94
    s_add_u32 s96, s96, 0x1000000
    v_lshlrev_b32 v14, 9, v1
    s_cmp_ge_u32 s33, 2
    s_cbranch_scc1 ln1_nt
    s_cmp_eq_u32 s33, 0
    s_cbranch_scc1 ln1_xs
    buffer_load_dword v8, v13, s[44:47], s95 offen
    s_branch ln1_x2
ln1_xs:
    buffer_load_dword v8, v14, s[88:91], s96 offen
ln1_x2:
    s_waitcnt vmcnt(1)
    s_branch ln1_nt2
ln1_nt:
    s_waitcnt vmcnt(0)
ln1_nt2:
    v_perm_b32 v26, v20, v16, s57
    ds_write_b32 v25, v26 offset:0
    v_perm_b32 v27, v20, v16, s58
    ds_write_b32 v25, v27 offset:1024
    v_perm_b32 v26, v21, v17, s57
    ds_write_b32 v25, v26 offset:2048
    v_perm_b32 v27, v21, v17, s58
    ds_write_b32 v25, v27 offset:3072
    v_perm_b32 v26, v22, v18, s57
    ds_write_b32 v25, v26 offset:4096
    v_perm_b32 v27, v22, v18, s58
    ds_write_b32 v25, v27 offset:5120
    v_perm_b32 v26, v23, v19, s57
    ds_write_b32 v25, v26 offset:6144
    v_perm_b32 v27, v23, v19, s58
    ds_write_b32 v25, v27 offset:7168
    s_lshl_b32 s56, s33, 11
    s_add_u32 s56, s56, 143360
    v_add_u32 v25, s56, v2
    s_waitcnt lgkmcnt(0)
    s_barrier
    ds_read_b128 v[88:91], v25
    ds_read_b128 v[92:95], v25 offset:1024
    s_waitcnt lgkmcnt(0)
    buffer_store_dwordx4 v[88:91], v2, s[52:55], s35 offen sc1
    buffer_store_dwordx4 v[92:95], v2, s[52:55], s35 offen offset:1024 sc1
    v_lshlrev_b32 v64, 16, v88
    v_and_b32 v65, 0xffff0000, v88
    v_lshlrev_b32 v66, 16, v89
    v_and_b32 v67, 0xffff0000, v89
    v_lshlrev_b32 v68, 16, v90
    v_and_b32 v69, 0xffff0000, v90
    v_lshlrev_b32 v70, 16, v91
    v_and_b32 v71, 0xffff0000, v91
    v_lshlrev_b32 v72, 16, v92
    v_and_b32 v73, 0xffff0000, v92
    v_lshlrev_b32 v74, 16, v93
    v_and_b32 v75, 0xffff0000, v93
    v_lshlrev_b32 v76, 16, v94
    v_and_b32 v77, 0xffff0000, v94
    v_lshlrev_b32 v78, 16, v95
    v_and_b32 v79, 0xffff0000, v95
    v_pk_fma_f32 v[32:33], v[48:49], v[64:65], v[32:33]
    v_pk_fma_f32 v[40:41], v[56:57], v[72:73], v[40:41]
    v_pk_fma_f32 v[34:35], v[50:51], v[66:67], v[34:35]
    v_pk_fma_f32 v[42:43], v[58:59], v[74:75], v[42:43]
    v_pk_fma_f32 v[36:37], v[52:53], v[68:69], v[36:37]
    v_pk_fma_f32 v[44:45], v[60:61], v[76:77], v[44:45]
    v_pk_fma_f32 v[38:39], v[54:55], v[70:71], v[38:39]
    v_pk_fma_f32 v[46:47], v[62:63], v[78:79], v[46:47]
    v_cvt_pk_bf16_f32 v80, v32, v33
    v_cvt_pk_bf16_f32 v84, v40, v41
    v_cvt_pk_bf16_f32 v81, v34, v35
    v_cvt_pk_bf16_f32 v85, v42, v43
    v_cvt_pk_bf16_f32 v82, v36, v37
    v_cvt_pk_bf16_f32 v86, v44, v45
    v_cvt_pk_bf16_f32 v83, v38, v39
    v_cvt_pk_bf16_f32 v87, v46, v47
    buffer_store_dwordx4 v[80:83], v2, s[44:47], s35 offen
    buffer_store_dwordx4 v[84:87], v2, s[44:47], s35 offen offset:1024
    v_lshlrev_b32 v32, 16, v80
    v_and_b32 v33, 0xffff0000, v80
    v_lshlrev_b32 v34, 16, v81
    v_and_b32 v35, 0xffff0000, v81
    v_lshlrev_b32 v36, 16, v82
    v_and_b32 v37, 0xffff0000, v82
    v_lshlrev_b32 v38, 16, v83
    v_and_b32 v39, 0xffff0000, v83
    v_lshlrev_b32 v40, 16, v84
    v_and_b32 v41, 0xffff0000, v84
    v_lshlrev_b32 v42, 16, v85
    v_and_b32 v43, 0xffff0000, v85
    v_lshlrev_b32 v44, 16, v86
    v_and_b32 v45, 0xffff0000, v86
    v_lshlrev_b32 v46, 16, v87
    v_and_b32 v47, 0xffff0000, v87
    v_readfirstlane_b32 s56, v32
    v_readfirstlane_b32 s58, v40
    s_nop 0
    v_pk_add_f32 v[48:49], v[32:33], s[56:57] op_sel_hi:[1,0] neg_lo:[0,1] neg_hi:[0,1]
    v_pk_add_f32 v[50:51], v[34:35], s[56:57] op_sel_hi:[1,0] neg_lo:[0,1] neg_hi:[0,1]
    v_pk_add_f32 v[52:53], v[36:37], s[56:57] op_sel_hi:[1,0] neg_lo:[0,1] neg_hi:[0,1]
    v_pk_add_f32 v[54:55], v[38:39], s[56:57] op_sel_hi:[1,0] neg_lo:[0,1] neg_hi:[0,1]
    v_pk_add_f32 v[56:57], v[40:41], s[58:59] op_sel_hi:[1,0] neg_lo:[0,1] neg_hi:[0,1]
    v_pk_add_f32 v[58:59], v[42:43], s[58:59] op_sel_hi:[1,0] neg_lo:[0,1] neg_hi:[0,1]
    v_pk_add_f32 v[60:61], v[44:45], s[58:59] op_sel_hi:[1,0] neg_lo:[0,1] neg_hi:[0,1]
    v_pk_add_f32 v[62:63], v[46:47], s[58:59] op_sel_hi:[1,0] neg_lo:[0,1] neg_hi:[0,1]
    v_pk_add_f32 v[16:17], v[48:49], v[50:51]
    v_pk_mul_f32 v[18:19], v[48:49], v[48:49]
    v_pk_add_f32 v[20:21], v[56:57], v[58:59]
    v_pk_mul_f32 v[22:23], v[56:57], v[56:57]
    v_pk_add_f32 v[16:17], v[16:17], v[52:53]
    v_pk_fma_f32 v[18:19], v[50:51], v[50:51], v[18:19]
    v_pk_add_f32 v[20:21], v[20:21], v[60:61]
    v_pk_fma_f32 v[22:23], v[58:59], v[58:59], v[22:23]
    v_pk_add_f32 v[16:17], v[16:17], v[54:55]
    v_pk_fma_f32 v[18:19], v[52:53], v[52:53], v[18:19]
    v_pk_add_f32 v[20:21], v[20:21], v[62:63]
    v_pk_fma_f32 v[22:23], v[60:61], v[60:61], v[22:23]
    v_pk_fma_f32 v[18:19], v[54:55], v[54:55], v[18:19]
    v_add_f32 v16, v16, v17
    v_pk_fma_f32 v[22:23], v[62:63], v[62:63], v[22:23]
    v_add_f32 v20, v20, v21
    v_add_f32 v18, v18, v19
    v_add_f32 v22, v22, v23
    v_add_f32_dpp v16, v16, v16 row_shr:1 row_mask:0xf bank_mask:0xf
    v_add_f32_dpp v18, v18, v18 row_shr:1 row_mask:0xf bank_mask:0xf
    v_add_f32_dpp v20, v20, v20 row_shr:1 row_mask:0xf bank_mask:0xf
    v_add_f32_dpp v22, v22, v22 row_shr:1 row_mask:0xf bank_mask:0xf
    v_add_f32_dpp v16, v16, v16 row_shr:2 row_mask:0xf bank_mask:0xf
    v_add_f32_dpp v18, v18, v18 row_shr:2 row_mask:0xf bank_mask:0xf
    v_add_f32_dpp v20, v20, v20 row_shr:2 row_mask:0xf bank_mask:0xf
    v_add_f32_dpp v22, v22, v22 row_shr:2 row_mask:0xf bank_mask:0xf
    v_add_f32_dpp v16, v16, v16 row_shr:4 row_mask:0xf bank_mask:0xf
    v_add_f32_dpp v18, v18, v18 row_shr:4 row_mask:0xf bank_mask:0xf
    v_add_f32_dpp v20, v20, v20 row_shr:4 row_mask:0xf bank_mask:0xf
    v_add_f32_dpp v22, v22, v22 row_shr:4 row_mask:0xf bank_mask:0xf
    v_add_f32_dpp v16, v16, v16 row_shr:8 row_mask:0xf bank_mask:0xf
    v_add_f32_dpp v18, v18, v18 row_shr:8 row_mask:0xf bank_mask:0xf
    v_add_f32_dpp v20, v20, v20 row_shr:8 row_mask:0xf bank_mask:0xf
    v_add_f32_dpp v22, v22, v22 row_shr:8 row_mask:0xf bank_mask:0xf
    v_add_f32_dpp v16, v16, v16 row_bcast:15 row_mask:0xa bank_mask:0xf
    v_add_f32_dpp v18, v18, v18 row_bcast:15 row_mask:0xa bank_mask:0xf
    v_add_f32_dpp v20, v20, v20 row_bcast:15 row_mask:0xa bank_mask:0xf
    v_add_f32_dpp v22, v22, v22 row_bcast:15 row_mask:0xa bank_mask:0xf
    v_add_f32_dpp v16, v16, v16 row_bcast:31 row_mask:0xc bank_mask:0xf
    v_add_f32_dpp v18, v18, v18 row_bcast:31 row_mask:0xc bank_mask:0xf
    v_add_f32_dpp v20, v20, v20 row_bcast:31 row_mask:0xc bank_mask:0xf
    v_add_f32_dpp v22, v22, v22 row_bcast:31 row_mask:0xc bank_mask:0xf
    v_readlane_b32 s60, v16, 63
    v_readlane_b32 s61, v18, 63
    v_readlane_b32 s62, v20, 63
    v_readlane_b32 s63, v22, 63
    v_mov_b32 v16, s60
    v_mov_b32 v18, s61
    v_mov_b32 v20, s62
    v_mov_b32 v22, s63
    v_mul_f32 v16, 0x3b000000, v16
    v_mul_f32 v18, 0x3b000000, v18
    v_mul_f32 v20, 0x3b000000, v20
    v_mul_f32 v22, 0x3b000000, v22
    v_fma_f32 v18, -v16, v16, v18
    v_fma_f32 v22, -v20, v20, v22
    v_max_f32 v18, 0, v18
    v_max_f32 v22, 0, v22
    v_add_f32 v18, 0x3727c5ac, v18
    v_add_f32 v22, 0x3727c5ac, v22
    v_rsq_f32 v18, v18
    v_rsq_f32 v22, v22
    v_mul_f32 v16, v16, v18
    v_mul_f32 v20, v20, v22
    v_pk_fma_f32 v[48:49], v[48:49], v[18:19], v[16:17] op_sel_hi:[1,0,0] neg_lo:[0,0,1] neg_hi:[0,0,1]
    v_pk_fma_f32 v[50:51], v[50:51], v[18:19], v[16:17] op_sel_hi:[1,0,0] neg_lo:[0,0,1] neg_hi:[0,0,1]
    v_pk_fma_f32 v[52:53], v[52:53], v[18:19], v[16:17] op_sel_hi:[1,0,0] neg_lo:[0,0,1] neg_hi:[0,0,1]
    v_pk_fma_f32 v[54:55], v[54:55], v[18:19], v[16:17] op_sel_hi:[1,0,0] neg_lo:[0,0,1] neg_hi:[0,0,1]
    v_pk_fma_f32 v[56:57], v[56:57], v[22:23], v[20:21] op_sel_hi:[1,0,0] neg_lo:[0,0,1] neg_hi:[0,0,1]
    v_pk_fma_f32 v[58:59], v[58:59], v[22:23], v[20:21] op_sel_hi:[1,0,0] neg_lo:[0,0,1] neg_hi:[0,0,1]
    v_pk_fma_f32 v[60:61], v[60:61], v[22:23], v[20:21] op_sel_hi:[1,0,0] neg_lo:[0,0,1] neg_hi:[0,0,1]
    v_pk_fma_f32 v[62:63], v[62:63], v[22:23], v[20:21] op_sel_hi:[1,0,0] neg_lo:[0,0,1] neg_hi:[0,0,1]
    v_cvt_pk_bf16_f32 v24, v48, v49
    v_cvt_pk_bf16_f32 v28, v56, v57
    v_cvt_pk_bf16_f32 v25, v50, v51
    v_cvt_pk_bf16_f32 v29, v58, v59
    v_cvt_pk_bf16_f32 v26, v52, v53
    v_cvt_pk_bf16_f32 v30, v60, v61
    v_cvt_pk_bf16_f32 v27, v54, v55
    v_cvt_pk_bf16_f32 v31, v62, v63
    s_lshl_b32 s56, s33, 1
    s_mul_i32 s56, s56, 1088
    s_add_u32 s56, s56, 114688
    v_add_u32 v16, s56, v2
    ds_write_b128 v16, v[24:27]
    ds_write_b128 v16, v[28:31] offset:1088
    v_and_b32 v16, 7, v1
    v_lshrrev_b32 v17, 3, v1
    v_mul_u32_u24 v18, 1088, v16
    v_lshlrev_b32 v19, 4, v17
    v_add_u32 v18, v18, v19
    s_lshl_b32 s56, s33, 8
    s_add_u32 s56, s56, 114688
    v_add_u32 v18, s56, v18
    v_lshlrev_b32 v16, 4, v16
    v_lshlrev_b32 v17, 9, v17
    v_add_u32 v16, v16, v17
    s_lshr_b32 s56, s32, 5
    s_lshl_b32 s56, s56, 15
    s_and_b32 s57, s32, 31
    s_lshl_b32 s57, s57, 4
    s_add_u32 s56, s56, s57
    s_lshl_b32 s57, s33, 13
    s_add_u32 s56, s56, s57
    s_add_u32 s57, s56, 4096
    s_waitcnt lgkmcnt(0)
    s_barrier
    ds_read_b128 v[24:27], v18
    ds_read_b128 v[28:31], v18 offset:128
    s_waitcnt lgkmcnt(0)
    buffer_store_dwordx4 v[24:27], v16, s[48:51], s56 offen
    buffer_store_dwordx4 v[28:31], v16, s[48:51], s57 offen
    s_mov_b32 s72, 0
    s_mov_b32 s73, 1
    s_mov_b32 s74, 2
    s_mov_b32 s75, 3
    s_mov_b32 s76, 4
    s_mov_b32 s77, 5
    s_mov_b32 s78, 6
    s_mov_b32 s79, 7
    s_mov_b32 s70, 0
chain_pass:
    s_add_u32 s36, s28, 0x1000000
    s_addc_u32 s37, s29, 0
    s_mov_b32 s38, 0x200000
    s_mov_b32 s39, 0x20000
    s_mov_b32 s92, s20
    s_mov_b32 s93, s21
    s_mov_b32 s94, 0x1c0000
    s_mov_b32 s95, 0x20000
    s_mov_b32 s40, s18
    s_mov_b32 s41, s19
    s_mov_b32 s42, 0x1c0000
    s_mov_b32 s43, 0x20000
    s_cmp_ge_u32 s33, 2
    s_cselect_b32 s40, s92, s40
    s_cselect_b32 s41, s93, s41
    s_and_b32 s53, s33, 1
    s_mul_i32 s54, s31, 224
    s_mul_i32 s56, s53, 114688
    s_add_u32 s54, s54, s56
    s_mov_b32 s55, 4682
    v_mul_lo_u32 v9, v1, s55
    v_lshrrev_b32 v9, 16, v9
    v_mul_u32_u24 v16, 14, v9
    v_sub_u32 v16, v1, v16
    v_mul_u32_u24 v9, 3584, v9
    v_lshlrev_b32 v16, 4, v16
    v_add_u32 v9, v9, v16
    s_lshr_b32 s56, s33, 1
    s_mov_b32 s98, 0x00ffffff
    s_and_b32 s53, s33, 1
    s_mul_i32 s55, s53, 7168
    s_lshr_b32 s56, s33, 1
    s_mul_i32 s56, s56, 15232
    s_add_u32 s55, s55, s56
    s_add_u32 s57, s55, 6272
    s_cmp_eq_u32 s33, 3
    s_cselect_b32 s57, 14336, s57
    v_lshrrev_b32 v16, 4, v1
    v_and_b32 v17, 1, v16
    v_lshrrev_b32 v16, 1, v16
    v_lshlrev_b32 v18, 3, v16
    v_bfe_u32 v19, v1, 2, 2
    v_add_u32 v18, v18, v19
    v_mul_u32_u24 v18, 224, v18
    v_mul_u32_u24 v19, 15232, v17
    v_add_u32 v18, v18, v19
    v_and_b32 v19, 3, v1
    v_lshlrev_b32 v19, 3, v19
    v_add_u32 v3, v18, v19
    v_add_u32 v4, 57344, v3
    v_add_u32 v10, 114688, v3
    v_and_b32 v16, v16, v17
    v_mul_u32_u24 v16, 14336, v16
    v_sub_u32 v11, v3, v16
    v_sub_u32 v12, v4, v16
    v_sub_u32 v14, v10, v16
    s_waitcnt vmcnt(0)
    s_barrier
    s_add_u32 s71, s71, 1
    s_cmp_lg_u32 s33, 0
    s_cbranch_scc1 ts_2_n
    v_mov_b32 v6, s71
    s_lshl_b32 s68, s31, 2
    s_mov_b64 exec, 1
    buffer_store_dword v6, v7, s[64:67], s68 offen
    s_mov_b64 exec, -1
ts_2_n:
    s_lshl_b32 s68, s33, 2
    s_lshl_b32 s68, 15, s68
    s_mov_b32 s69, 0
ts_2_p:

    buffer_load_dword v6, v5, s[64:67], 0 offen sc1
    s_add_u32 s69, s69, 1
    s_cmp_gt_u32 s69, 200000
    s_cbranch_scc1 ts_2_w
    s_waitcnt vmcnt(0)
    v_cmp_gt_u32 vcc, s71, v6
    s_nop 0
    s_and_b32 s63, vcc_lo, s68
    s_cmp_lg_u32 s63, 0
    s_cbranch_scc1 ts_2_p
ts_2_w:

    s_lshl_b32 s34, s30, 2
    s_add_u32 s34, s34, s33
    s_lshl_b32 s52, s34, 15
    s_lshl_b32 s53, s72, 12
    s_add_u32 s53, s53, s52
    buffer_load_dwordx4 v[128:131], v2, s[36:39], s53 offen offset:0 sc1
    buffer_load_dwordx4 v[132:135], v2, s[36:39], s53 offen offset:1024 sc1
    buffer_load_dwordx4 v[136:139], v2, s[36:39], s53 offen offset:2048 sc1
    buffer_load_dwordx4 v[140:143], v2, s[36:39], s53 offen offset:3072 sc1
    s_lshl_b32 s53, s73, 12
    s_add_u32 s53, s53, s52
    buffer_load_dwordx4 v[144:147], v2, s[36:39], s53 offen offset:0 sc1
    buffer_load_dwordx4 v[148:151], v2, s[36:39], s53 offen offset:1024 sc1
    buffer_load_dwordx4 v[152:155], v2, s[36:39], s53 offen offset:2048 sc1
    buffer_load_dwordx4 v[156:159], v2, s[36:39], s53 offen offset:3072 sc1
    s_and_b32 s53, s31, 7
    s_mul_i32 s53, s53, 112
    s_mul_i32 s56, s33, 28
    s_add_u32 s53, s53, s56
    s_lshl_b32 s61, s53, 11
    s_cmp_eq_u32 s70, 0
    s_cselect_b64 vcc, -1, 0
    s_add_u32 s44, s28, 0x2000000
    s_addc_u32 s45, s29, 0
    s_mov_b32 s46, 0x700000
    s_mov_b32 s47, 0x20000
    s_add_u32 s48, s28, 0xc00000
    s_addc_u32 s49, s29, 0
    s_mov_b32 s50, 0x1c0000
    s_mov_b32 s51, 0x20000
    s_waitcnt vmcnt(4)
    ds_read_b64_tr_b16 a[224:225], v3 offset:0
    ds_read_b64_tr_b16 a[226:227], v3 offset:896
    ds_read_b64_tr_b16 a[228:229], v3 offset:32
    ds_read_b64_tr_b16 a[230:231], v3 offset:928
    ds_read_b64_tr_b16 a[232:233], v3 offset:64
    ds_read_b64_tr_b16 a[234:235], v3 offset:960
    ds_read_b64_tr_b16 a[236:237], v3 offset:96
    ds_read_b64_tr_b16 a[238:239], v3 offset:992
    ds_read_b64_tr_b16 a[240:241], v3 offset:128
    ds_read_b64_tr_b16 a[242:243], v3 offset:1024
    ds_read_b64_tr_b16 a[244:245], v3 offset:160
    ds_read_b64_tr_b16 a[246:247], v3 offset:1056
    s_waitcnt lgkmcnt(8)
    v_mfma_f32_32x32x16_bf16 v[16:31], a[224:227], v[128:131], 0
    ds_read_b64_tr_b16 a[248:249], v3 offset:192
    ds_read_b64_tr_b16 a[250:251], v3 offset:1088
    v_mfma_f32_32x32x16_bf16 v[32:47], a[228:231], v[128:131], 0
    s_lshl_b32 s53, s74, 12
    s_add_u32 s53, s53, s52
    buffer_load_dwordx4 v[160:163], v2, s[36:39], s53 offen offset:0 sc1
    ds_read_b64_tr_b16 a[252:253], v3 offset:3584
    ds_read_b64_tr_b16 a[254:255], v3 offset:4480
    s_waitcnt lgkmcnt(8)
    v_mfma_f32_32x32x16_bf16 v[48:63], a[232:235], v[128:131], 0
    ds_read_b64_tr_b16 a[224:225], v3 offset:3616
    ds_read_b64_tr_b16 a[226:227], v3 offset:4512
    v_mfma_f32_32x32x16_bf16 v[64:79], a[236:239], v[128:131], 0
    buffer_load_dwordx4 v[164:167], v2, s[36:39], s53 offen offset:1024 sc1
    ds_read_b64_tr_b16 a[228:229], v3 offset:3648
    ds_read_b64_tr_b16 a[230:231], v3 offset:4544
    s_waitcnt lgkmcnt(8)
    v_mfma_f32_32x32x16_bf16 v[80:95], a[240:243], v[128:131], 0
    ds_read_b64_tr_b16 a[232:233], v3 offset:3680
    ds_read_b64_tr_b16 a[234:235], v3 offset:4576
    v_mfma_f32_32x32x16_bf16 v[96:111], a[244:247], v[128:131], 0
    buffer_load_dwordx4 v[168:171], v2, s[36:39], s53 offen offset:2048 sc1
    ds_read_b64_tr_b16 a[236:237], v3 offset:3712
    ds_read_b64_tr_b16 a[238:239], v3 offset:4608
    s_waitcnt lgkmcnt(8)
    v_mfma_f32_32x32x16_bf16 v[112:127], a[248:251], v[128:131], 0
    ds_read_b64_tr_b16 a[240:241], v3 offset:3744
    ds_read_b64_tr_b16 a[242:243], v3 offset:4640
    v_mfma_f32_32x32x16_bf16 v[16:31], a[252:255], v[132:135], v[16:31]
    buffer_load_dwordx4 v[172:175], v2, s[36:39], s53 offen offset:3072 sc1
    ds_read_b64_tr_b16 a[244:245], v3 offset:3776
    ds_read_b64_tr_b16 a[246:247], v3 offset:4672
    s_waitcnt lgkmcnt(8)
    v_mfma_f32_32x32x16_bf16 v[32:47], a[224:227], v[132:135], v[32:47]
    ds_read_b64_tr_b16 a[248:249], v3 offset:7168
    ds_read_b64_tr_b16 a[250:251], v3 offset:8064
    v_mfma_f32_32x32x16_bf16 v[48:63], a[228:231], v[132:135], v[48:63]
    s_mul_i32 s60, s76, 229376
    s_add_u32 s60, s60, s54
    s_add_u32 m0, s55, 114688
    s_nop 0
    buffer_load_dwordx4 v9, s[40:43], s60 offen lds
    ds_read_b64_tr_b16 a[252:253], v3 offset:7200
    ds_read_b64_tr_b16 a[254:255], v3 offset:8096
    s_waitcnt lgkmcnt(8)
    v_mfma_f32_32x32x16_bf16 v[64:79], a[232:235], v[132:135], v[64:79]
    ds_read_b64_tr_b16 a[224:225], v3 offset:7232
    ds_read_b64_tr_b16 a[226:227], v3 offset:8128
    v_mfma_f32_32x32x16_bf16 v[80:95], a[236:239], v[132:135], v[80:95]
    s_add_u32 s60, s60, 14336
    s_add_u32 m0, s55, 115584
    s_nop 0
    buffer_load_dwordx4 v9, s[40:43], s60 offen lds
    ds_read_b64_tr_b16 a[228:229], v3 offset:7264
    ds_read_b64_tr_b16 a[230:231], v3 offset:8160
    s_waitcnt lgkmcnt(8)
    v_mfma_f32_32x32x16_bf16 v[96:111], a[240:243], v[132:135], v[96:111]
    ds_read_b64_tr_b16 a[232:233], v3 offset:7296
    ds_read_b64_tr_b16 a[234:235], v3 offset:8192
    v_mfma_f32_32x32x16_bf16 v[112:127], a[244:247], v[132:135], v[112:127]
    s_add_u32 s60, s60, 14336
    s_add_u32 m0, s55, 116480
    s_nop 0
    buffer_load_dwordx4 v9, s[40:43], s60 offen lds
    ds_read_b64_tr_b16 a[236:237], v3 offset:7328
    ds_read_b64_tr_b16 a[238:239], v3 offset:8224
    s_waitcnt lgkmcnt(8)
    v_mfma_f32_32x32x16_bf16 v[16:31], a[248:251], v[136:139], v[16:31]
    ds_read_b64_tr_b16 a[240:241], v3 offset:7360
    ds_read_b64_tr_b16 a[242:243], v3 offset:8256
    v_mfma_f32_32x32x16_bf16 v[32:47], a[252:255], v[136:139], v[32:47]
    s_add_u32 s60, s60, 14336
    s_add_u32 m0, s55, 117376
    s_nop 0
    buffer_load_dwordx4 v9, s[40:43], s60 offen lds
    ds_read_b64_tr_b16 a[244:245], v3 offset:10752
    ds_read_b64_tr_b16 a[246:247], v11 offset:11648
    s_waitcnt lgkmcnt(8)
    v_mfma_f32_32x32x16_bf16 v[48:63], a[224:227], v[136:139], v[48:63]
    ds_read_b64_tr_b16 a[248:249], v3 offset:10784
    ds_read_b64_tr_b16 a[250:251], v11 offset:11680
    v_mfma_f32_32x32x16_bf16 v[64:79], a[228:231], v[136:139], v[64:79]
    s_add_u32 s60, s60, 14336
    s_add_u32 m0, s55, 118272
    s_nop 0
    buffer_load_dwordx4 v9, s[40:43], s60 offen lds
    ds_read_b64_tr_b16 a[252:253], v3 offset:10816
    ds_read_b64_tr_b16 a[254:255], v11 offset:11712
    s_waitcnt lgkmcnt(8)
    v_mfma_f32_32x32x16_bf16 v[80:95], a[232:235], v[136:139], v[80:95]
    ds_read_b64_tr_b16 a[224:225], v3 offset:10848
    ds_read_b64_tr_b16 a[226:227], v11 offset:11744
    v_mfma_f32_32x32x16_bf16 v[96:111], a[236:239], v[136:139], v[96:111]
    s_add_u32 s60, s60, 14336
    s_add_u32 m0, s55, 119168
    s_nop 0
    buffer_load_dwordx4 v9, s[40:43], s60 offen lds
    ds_read_b64_tr_b16 a[228:229], v3 offset:10880
    ds_read_b64_tr_b16 a[230:231], v11 offset:11776
    s_waitcnt lgkmcnt(8)
    v_mfma_f32_32x32x16_bf16 v[112:127], a[240:243], v[136:139], v[112:127]
    ds_read_b64_tr_b16 a[232:233], v3 offset:10912
    ds_read_b64_tr_b16 a[234:235], v11 offset:11808
    v_mfma_f32_32x32x16_bf16 v[16:31], a[244:247], v[140:143], v[16:31]
    s_add_u32 s60, s60, 14336
    s_add_u32 m0, s55, 120064
    s_mov_b32 exec_hi, s98
    buffer_load_dwordx4 v9, s[40:43], s60 offen lds
    s_mov_b32 exec_hi, -1
    ds_read_b64_tr_b16 a[236:237], v3 offset:10944
    ds_read_b64_tr_b16 a[238:239], v11 offset:11840
    s_waitcnt lgkmcnt(8)
    v_mfma_f32_32x32x16_bf16 v[32:47], a[248:251], v[140:143], v[32:47]
    s_waitcnt vmcnt(11)
    ds_read_b64_tr_b16 a[240:241], v3 offset:28672
    ds_read_b64_tr_b16 a[242:243], v3 offset:29568
    v_mfma_f32_32x32x16_bf16 v[48:63], a[252:255], v[140:143], v[48:63]
    s_add_u32 s60, s60, 14336
    s_add_u32 m0, s57, 114688
    s_mov_b32 exec_hi, s98
    buffer_load_dwordx4 v9, s[40:43], s60 offen lds
    s_mov_b32 exec_hi, -1
    ds_read_b64_tr_b16 a[244:245], v3 offset:28704
    ds_read_b64_tr_b16 a[246:247], v3 offset:29600
    s_waitcnt lgkmcnt(8)
    v_mfma_f32_32x32x16_bf16 v[64:79], a[224:227], v[140:143], v[64:79]
    s_lshl_b32 s53, s75, 12
    s_add_u32 s53, s53, s52
    buffer_load_dwordx4 v[176:179], v2, s[36:39], s53 offen offset:0 sc1
    ds_read_b64_tr_b16 a[248:249], v3 offset:28736
    ds_read_b64_tr_b16 a[250:251], v3 offset:29632
    v_mfma_f32_32x32x16_bf16 v[80:95], a[228:231], v[140:143], v[80:95]
    ds_read_b64_tr_b16 a[252:253], v3 offset:28768
    ds_read_b64_tr_b16 a[254:255], v3 offset:29664
    s_waitcnt lgkmcnt(8)
    v_mfma_f32_32x32x16_bf16 v[96:111], a[232:235], v[140:143], v[96:111]
    ds_read_b64_tr_b16 a[224:225], v3 offset:28800
    ds_read_b64_tr_b16 a[226:227], v3 offset:29696
    v_mfma_f32_32x32x16_bf16 v[112:127], a[236:239], v[140:143], v[112:127]
    ds_read_b64_tr_b16 a[228:229], v3 offset:28832
    ds_read_b64_tr_b16 a[230:231], v3 offset:29728
    s_waitcnt lgkmcnt(8)
    v_mfma_f32_32x32x16_bf16 v[16:31], a[240:243], v[144:147], v[16:31]
    ds_read_b64_tr_b16 a[232:233], v3 offset:28864
    ds_read_b64_tr_b16 a[234:235], v3 offset:29760
    v_mfma_f32_32x32x16_bf16 v[32:47], a[244:247], v[144:147], v[32:47]
    ds_read_b64_tr_b16 a[236:237], v3 offset:32256
    ds_read_b64_tr_b16 a[238:239], v3 offset:33152
    s_waitcnt lgkmcnt(8)
    v_mfma_f32_32x32x16_bf16 v[48:63], a[248:251], v[144:147], v[48:63]
    buffer_load_dwordx4 v[180:183], v2, s[36:39], s53 offen offset:1024 sc1
    ds_read_b64_tr_b16 a[240:241], v3 offset:32288
    ds_read_b64_tr_b16 a[242:243], v3 offset:33184
    v_mfma_f32_32x32x16_bf16 v[64:79], a[252:255], v[144:147], v[64:79]
    ds_read_b64_tr_b16 a[244:245], v3 offset:32320
    ds_read_b64_tr_b16 a[246:247], v3 offset:33216
    s_waitcnt lgkmcnt(8)
    v_mfma_f32_32x32x16_bf16 v[80:95], a[224:227], v[144:147], v[80:95]
    ds_read_b64_tr_b16 a[248:249], v3 offset:32352
    ds_read_b64_tr_b16 a[250:251], v3 offset:33248
    v_mfma_f32_32x32x16_bf16 v[96:111], a[228:231], v[144:147], v[96:111]
    ds_read_b64_tr_b16 a[252:253], v3 offset:32384
    ds_read_b64_tr_b16 a[254:255], v3 offset:33280
    s_waitcnt lgkmcnt(8)
    v_mfma_f32_32x32x16_bf16 v[112:127], a[232:235], v[144:147], v[112:127]
    ds_read_b64_tr_b16 a[224:225], v3 offset:32416
    ds_read_b64_tr_b16 a[226:227], v3 offset:33312
    v_mfma_f32_32x32x16_bf16 v[16:31], a[236:239], v[148:151], v[16:31]
    ds_read_b64_tr_b16 a[228:229], v3 offset:32448
    ds_read_b64_tr_b16 a[230:231], v3 offset:33344
    s_waitcnt lgkmcnt(8)
    v_mfma_f32_32x32x16_bf16 v[32:47], a[240:243], v[148:151], v[32:47]
    buffer_load_dwordx4 v[184:187], v2, s[36:39], s53 offen offset:2048 sc1
    ds_read_b64_tr_b16 a[232:233], v3 offset:35840
    ds_read_b64_tr_b16 a[234:235], v3 offset:36736
    v_mfma_f32_32x32x16_bf16 v[48:63], a[244:247], v[148:151], v[48:63]
    ds_read_b64_tr_b16 a[236:237], v3 offset:35872
    ds_read_b64_tr_b16 a[238:239], v3 offset:36768
    s_waitcnt lgkmcnt(8)
    v_mfma_f32_32x32x16_bf16 v[64:79], a[248:251], v[148:151], v[64:79]
    ds_read_b64_tr_b16 a[240:241], v3 offset:35904
    ds_read_b64_tr_b16 a[242:243], v3 offset:36800
    v_mfma_f32_32x32x16_bf16 v[80:95], a[252:255], v[148:151], v[80:95]
    ds_read_b64_tr_b16 a[244:245], v3 offset:35936
    ds_read_b64_tr_b16 a[246:247], v3 offset:36832
    s_waitcnt lgkmcnt(8)
    v_mfma_f32_32x32x16_bf16 v[96:111], a[224:227], v[148:151], v[96:111]
    ds_read_b64_tr_b16 a[248:249], v3 offset:35968
    ds_read_b64_tr_b16 a[250:251], v3 offset:36864
    v_mfma_f32_32x32x16_bf16 v[112:127], a[228:231], v[148:151], v[112:127]
    ds_read_b64_tr_b16 a[252:253], v3 offset:36000
    ds_read_b64_tr_b16 a[254:255], v3 offset:36896
    s_waitcnt lgkmcnt(8)
    v_mfma_f32_32x32x16_bf16 v[16:31], a[232:235], v[152:155], v[16:31]
    buffer_load_dwordx4 v[188:191], v2, s[36:39], s53 offen offset:3072 sc1
    ds_read_b64_tr_b16 a[224:225], v3 offset:36032
    ds_read_b64_tr_b16 a[226:227], v3 offset:36928
    v_mfma_f32_32x32x16_bf16 v[32:47], a[236:239], v[152:155], v[32:47]
    ds_read_b64_tr_b16 a[228:229], v3 offset:39424
    ds_read_b64_tr_b16 a[230:231], v11 offset:40320
    s_waitcnt lgkmcnt(8)
    v_mfma_f32_32x32x16_bf16 v[48:63], a[240:243], v[152:155], v[48:63]
    ds_read_b64_tr_b16 a[232:233], v3 offset:39456
    ds_read_b64_tr_b16 a[234:235], v11 offset:40352
    v_mfma_f32_32x32x16_bf16 v[64:79], a[244:247], v[152:155], v[64:79]
    ds_read_b64_tr_b16 a[236:237], v3 offset:39488
    ds_read_b64_tr_b16 a[238:239], v11 offset:40384
    s_waitcnt lgkmcnt(8)
    v_mfma_f32_32x32x16_bf16 v[80:95], a[248:251], v[152:155], v[80:95]
    ds_read_b64_tr_b16 a[240:241], v3 offset:39520
    ds_read_b64_tr_b16 a[242:243], v11 offset:40416
    v_mfma_f32_32x32x16_bf16 v[96:111], a[252:255], v[152:155], v[96:111]
    ds_read_b64_tr_b16 a[244:245], v3 offset:39552
    ds_read_b64_tr_b16 a[246:247], v11 offset:40448
    s_waitcnt lgkmcnt(8)
    v_mfma_f32_32x32x16_bf16 v[112:127], a[224:227], v[152:155], v[112:127]
    ds_read_b64_tr_b16 a[248:249], v3 offset:39584
    ds_read_b64_tr_b16 a[250:251], v11 offset:40480
    v_mfma_f32_32x32x16_bf16 v[16:31], a[228:231], v[156:159], v[16:31]
    ds_read_b64_tr_b16 a[252:253], v3 offset:39616
    ds_read_b64_tr_b16 a[254:255], v11 offset:40512
    s_waitcnt lgkmcnt(8)
    v_mfma_f32_32x32x16_bf16 v[32:47], a[232:235], v[156:159], v[32:47]
    s_waitcnt vmcnt(12)
    s_barrier
    ds_read_b64_tr_b16 a[224:225], v4 offset:0
    ds_read_b64_tr_b16 a[226:227], v4 offset:896
    v_mfma_f32_32x32x16_bf16 v[48:63], a[236:239], v[156:159], v[48:63]
    ds_read_b64_tr_b16 a[228:229], v4 offset:32
    ds_read_b64_tr_b16 a[230:231], v4 offset:928
    s_waitcnt lgkmcnt(8)
    v_mfma_f32_32x32x16_bf16 v[64:79], a[240:243], v[156:159], v[64:79]
    s_lshl_b32 s53, s76, 12
    s_add_u32 s53, s53, s52
    buffer_load_dwordx4 v[192:195], v2, s[36:39], s53 offen offset:0 sc1
    ds_read_b64_tr_b16 a[232:233], v4 offset:64
    ds_read_b64_tr_b16 a[234:235], v4 offset:960
    v_mfma_f32_32x32x16_bf16 v[80:95], a[244:247], v[156:159], v[80:95]
    ds_read_b64_tr_b16 a[236:237], v4 offset:96
    ds_read_b64_tr_b16 a[238:239], v4 offset:992
    s_waitcnt lgkmcnt(8)
    v_mfma_f32_32x32x16_bf16 v[96:111], a[248:251], v[156:159], v[96:111]
    buffer_load_dwordx4 v[196:199], v2, s[36:39], s53 offen offset:1024 sc1
    ds_read_b64_tr_b16 a[240:241], v4 offset:128
    ds_read_b64_tr_b16 a[242:243], v4 offset:1024
    v_mfma_f32_32x32x16_bf16 v[112:127], a[252:255], v[156:159], v[112:127]
    ds_read_b64_tr_b16 a[244:245], v4 offset:160
    ds_read_b64_tr_b16 a[246:247], v4 offset:1056
    s_waitcnt lgkmcnt(8)
    v_mfma_f32_32x32x16_bf16 v[16:31], a[224:227], v[160:163], v[16:31]
    buffer_load_dwordx4 v[200:203], v2, s[36:39], s53 offen offset:2048 sc1
    ds_read_b64_tr_b16 a[248:249], v4 offset:192
    ds_read_b64_tr_b16 a[250:251], v4 offset:1088
    v_mfma_f32_32x32x16_bf16 v[32:47], a[228:231], v[160:163], v[32:47]
    ds_read_b64_tr_b16 a[252:253], v4 offset:3584
    ds_read_b64_tr_b16 a[254:255], v4 offset:4480
    s_waitcnt lgkmcnt(8)
    v_mfma_f32_32x32x16_bf16 v[48:63], a[232:235], v[160:163], v[48:63]
    buffer_load_dwordx4 v[204:207], v2, s[36:39], s53 offen offset:3072 sc1
    ds_read_b64_tr_b16 a[224:225], v4 offset:3616
    ds_read_b64_tr_b16 a[226:227], v4 offset:4512
    v_mfma_f32_32x32x16_bf16 v[64:79], a[236:239], v[160:163], v[64:79]
    ds_read_b64_tr_b16 a[228:229], v4 offset:3648
    ds_read_b64_tr_b16 a[230:231], v4 offset:4544
    s_waitcnt lgkmcnt(8)
    v_mfma_f32_32x32x16_bf16 v[80:95], a[240:243], v[160:163], v[80:95]
    s_mul_i32 s60, s77, 229376
    s_add_u32 s60, s60, s54
    s_add_u32 m0, s55, 0
    s_nop 0
    buffer_load_dwordx4 v9, s[40:43], s60 offen lds
    ds_read_b64_tr_b16 a[232:233], v4 offset:3680
    ds_read_b64_tr_b16 a[234:235], v4 offset:4576
    v_mfma_f32_32x32x16_bf16 v[96:111], a[244:247], v[160:163], v[96:111]
    ds_read_b64_tr_b16 a[236:237], v4 offset:3712
    ds_read_b64_tr_b16 a[238:239], v4 offset:4608
    s_waitcnt lgkmcnt(8)
    v_mfma_f32_32x32x16_bf16 v[112:127], a[248:251], v[160:163], v[112:127]
    s_add_u32 s60, s60, 14336
    s_add_u32 m0, s55, 896
    s_nop 0
    buffer_load_dwordx4 v9, s[40:43], s60 offen lds
    ds_read_b64_tr_b16 a[240:241], v4 offset:3744
    ds_read_b64_tr_b16 a[242:243], v4 offset:4640
    v_mfma_f32_32x32x16_bf16 v[16:31], a[252:255], v[164:167], v[16:31]
    ds_read_b64_tr_b16 a[244:245], v4 offset:3776
    ds_read_b64_tr_b16 a[246:247], v4 offset:4672
    s_waitcnt lgkmcnt(8)
    v_mfma_f32_32x32x16_bf16 v[32:47], a[224:227], v[164:167], v[32:47]
    s_add_u32 s60, s60, 14336
    s_add_u32 m0, s55, 1792
    s_nop 0
    buffer_load_dwordx4 v9, s[40:43], s60 offen lds
    ds_read_b64_tr_b16 a[248:249], v4 offset:7168
    ds_read_b64_tr_b16 a[250:251], v4 offset:8064
    v_mfma_f32_32x32x16_bf16 v[48:63], a[228:231], v[164:167], v[48:63]
    ds_read_b64_tr_b16 a[252:253], v4 offset:7200
    ds_read_b64_tr_b16 a[254:255], v4 offset:8096
    s_waitcnt lgkmcnt(8)
    v_mfma_f32_32x32x16_bf16 v[64:79], a[232:235], v[164:167], v[64:79]
    s_add_u32 s60, s60, 14336
    s_add_u32 m0, s55, 2688
    s_nop 0
    buffer_load_dwordx4 v9, s[40:43], s60 offen lds
    ds_read_b64_tr_b16 a[224:225], v4 offset:7232
    ds_read_b64_tr_b16 a[226:227], v4 offset:8128
    v_mfma_f32_32x32x16_bf16 v[80:95], a[236:239], v[164:167], v[80:95]
    ds_read_b64_tr_b16 a[228:229], v4 offset:7264
    ds_read_b64_tr_b16 a[230:231], v4 offset:8160
    s_waitcnt lgkmcnt(8)
    v_mfma_f32_32x32x16_bf16 v[96:111], a[240:243], v[164:167], v[96:111]
    s_add_u32 s60, s60, 14336
    s_add_u32 m0, s55, 3584
    s_nop 0
    buffer_load_dwordx4 v9, s[40:43], s60 offen lds
    ds_read_b64_tr_b16 a[232:233], v4 offset:7296
    ds_read_b64_tr_b16 a[234:235], v4 offset:8192
    v_mfma_f32_32x32x16_bf16 v[112:127], a[244:247], v[164:167], v[112:127]
    ds_read_b64_tr_b16 a[236:237], v4 offset:7328
    ds_read_b64_tr_b16 a[238:239], v4 offset:8224
    s_waitcnt lgkmcnt(8)
    v_mfma_f32_32x32x16_bf16 v[16:31], a[248:251], v[168:171], v[16:31]
    s_add_u32 s60, s60, 14336
    s_add_u32 m0, s55, 4480
    s_nop 0
    buffer_load_dwordx4 v9, s[40:43], s60 offen lds
    ds_read_b64_tr_b16 a[240:241], v4 offset:7360
    ds_read_b64_tr_b16 a[242:243], v4 offset:8256
    v_mfma_f32_32x32x16_bf16 v[32:47], a[252:255], v[168:171], v[32:47]
    ds_read_b64_tr_b16 a[244:245], v4 offset:10752
    ds_read_b64_tr_b16 a[246:247], v12 offset:11648
    s_waitcnt lgkmcnt(8)
    v_mfma_f32_32x32x16_bf16 v[48:63], a[224:227], v[168:171], v[48:63]
    s_add_u32 s60, s60, 14336
    s_add_u32 m0, s55, 5376
    s_mov_b32 exec_hi, s98
    buffer_load_dwordx4 v9, s[40:43], s60 offen lds
    s_mov_b32 exec_hi, -1
    ds_read_b64_tr_b16 a[248:249], v4 offset:10784
    ds_read_b64_tr_b16 a[250:251], v12 offset:11680
    v_mfma_f32_32x32x16_bf16 v[64:79], a[228:231], v[168:171], v[64:79]
    ds_read_b64_tr_b16 a[252:253], v4 offset:10816
    ds_read_b64_tr_b16 a[254:255], v12 offset:11712
    s_waitcnt lgkmcnt(8)
    v_mfma_f32_32x32x16_bf16 v[80:95], a[232:235], v[168:171], v[80:95]
    s_add_u32 s60, s60, 14336
    s_add_u32 m0, s57, 0
    s_mov_b32 exec_hi, s98
    buffer_load_dwordx4 v9, s[40:43], s60 offen lds
    s_mov_b32 exec_hi, -1
    ds_read_b64_tr_b16 a[224:225], v4 offset:10848
    ds_read_b64_tr_b16 a[226:227], v12 offset:11744
    v_mfma_f32_32x32x16_bf16 v[96:111], a[236:239], v[168:171], v[96:111]
    ds_read_b64_tr_b16 a[228:229], v4 offset:10880
    ds_read_b64_tr_b16 a[230:231], v12 offset:11776
    s_waitcnt lgkmcnt(8)
    v_mfma_f32_32x32x16_bf16 v[112:127], a[240:243], v[168:171], v[112:127]
    ds_read_b64_tr_b16 a[232:233], v4 offset:10912
    ds_read_b64_tr_b16 a[234:235], v12 offset:11808
    v_mfma_f32_32x32x16_bf16 v[16:31], a[244:247], v[172:175], v[16:31]
    ds_read_b64_tr_b16 a[236:237], v4 offset:10944
    ds_read_b64_tr_b16 a[238:239], v12 offset:11840
    s_waitcnt lgkmcnt(8)
    v_mfma_f32_32x32x16_bf16 v[32:47], a[248:251], v[172:175], v[32:47]
    s_waitcnt vmcnt(12)
    s_barrier
    ds_read_b64_tr_b16 a[240:241], v4 offset:28672
    ds_read_b64_tr_b16 a[242:243], v4 offset:29568
    v_mfma_f32_32x32x16_bf16 v[48:63], a[252:255], v[172:175], v[48:63]
    ds_read_b64_tr_b16 a[244:245], v4 offset:28704
    ds_read_b64_tr_b16 a[246:247], v4 offset:29600
    s_waitcnt lgkmcnt(8)
    v_mfma_f32_32x32x16_bf16 v[64:79], a[224:227], v[172:175], v[64:79]
    s_lshl_b32 s53, s77, 12
    s_add_u32 s53, s53, s52
    buffer_load_dwordx4 v[208:211], v2, s[36:39], s53 offen offset:0 sc1
    ds_read_b64_tr_b16 a[248:249], v4 offset:28736
    ds_read_b64_tr_b16 a[250:251], v4 offset:29632
    v_mfma_f32_32x32x16_bf16 v[80:95], a[228:231], v[172:175], v[80:95]
    ds_read_b64_tr_b16 a[252:253], v4 offset:28768
    ds_read_b64_tr_b16 a[254:255], v4 offset:29664
    s_waitcnt lgkmcnt(8)
    v_mfma_f32_32x32x16_bf16 v[96:111], a[232:235], v[172:175], v[96:111]
    buffer_load_dwordx4 v[212:215], v2, s[36:39], s53 offen offset:1024 sc1
    ds_read_b64_tr_b16 a[224:225], v4 offset:28800
    ds_read_b64_tr_b16 a[226:227], v4 offset:29696
    v_mfma_f32_32x32x16_bf16 v[112:127], a[236:239], v[172:175], v[112:127]
    ds_read_b64_tr_b16 a[228:229], v4 offset:28832
    ds_read_b64_tr_b16 a[230:231], v4 offset:29728
    s_waitcnt lgkmcnt(8)
    v_mfma_f32_32x32x16_bf16 v[16:31], a[240:243], v[176:179], v[16:31]
    buffer_load_dwordx4 v[216:219], v2, s[36:39], s53 offen offset:2048 sc1
    ds_read_b64_tr_b16 a[232:233], v4 offset:28864
    ds_read_b64_tr_b16 a[234:235], v4 offset:29760
    v_mfma_f32_32x32x16_bf16 v[32:47], a[244:247], v[176:179], v[32:47]
    ds_read_b64_tr_b16 a[236:237], v4 offset:32256
    ds_read_b64_tr_b16 a[238:239], v4 offset:33152
    s_waitcnt lgkmcnt(8)
    v_mfma_f32_32x32x16_bf16 v[48:63], a[248:251], v[176:179], v[48:63]
    buffer_load_dwordx4 v[220:223], v2, s[36:39], s53 offen offset:3072 sc1
    ds_read_b64_tr_b16 a[240:241], v4 offset:32288
    ds_read_b64_tr_b16 a[242:243], v4 offset:33184
    v_mfma_f32_32x32x16_bf16 v[64:79], a[252:255], v[176:179], v[64:79]
    ds_read_b64_tr_b16 a[244:245], v4 offset:32320
    ds_read_b64_tr_b16 a[246:247], v4 offset:33216
    s_waitcnt lgkmcnt(8)
    v_mfma_f32_32x32x16_bf16 v[80:95], a[224:227], v[176:179], v[80:95]
    s_mul_i32 s60, s78, 229376
    s_add_u32 s60, s60, s54
    s_add_u32 m0, s55, 28672
    s_nop 0
    buffer_load_dwordx4 v9, s[40:43], s60 offen lds
    ds_read_b64_tr_b16 a[248:249], v4 offset:32352
    ds_read_b64_tr_b16 a[250:251], v4 offset:33248
    v_mfma_f32_32x32x16_bf16 v[96:111], a[228:231], v[176:179], v[96:111]
    ds_read_b64_tr_b16 a[252:253], v4 offset:32384
    ds_read_b64_tr_b16 a[254:255], v4 offset:33280
    s_waitcnt lgkmcnt(8)
    v_mfma_f32_32x32x16_bf16 v[112:127], a[232:235], v[176:179], v[112:127]
    s_add_u32 s60, s60, 14336
    s_add_u32 m0, s55, 29568
    s_nop 0
    buffer_load_dwordx4 v9, s[40:43], s60 offen lds
    ds_read_b64_tr_b16 a[224:225], v4 offset:32416
    ds_read_b64_tr_b16 a[226:227], v4 offset:33312
    v_mfma_f32_32x32x16_bf16 v[16:31], a[236:239], v[180:183], v[16:31]
    ds_read_b64_tr_b16 a[228:229], v4 offset:32448
    ds_read_b64_tr_b16 a[230:231], v4 offset:33344
    s_waitcnt lgkmcnt(8)
    v_mfma_f32_32x32x16_bf16 v[32:47], a[240:243], v[180:183], v[32:47]
    s_add_u32 s60, s60, 14336
    s_add_u32 m0, s55, 30464
    s_nop 0
    buffer_load_dwordx4 v9, s[40:43], s60 offen lds
    ds_read_b64_tr_b16 a[232:233], v4 offset:35840
    ds_read_b64_tr_b16 a[234:235], v4 offset:36736
    v_mfma_f32_32x32x16_bf16 v[48:63], a[244:247], v[180:183], v[48:63]
    ds_read_b64_tr_b16 a[236:237], v4 offset:35872
    ds_read_b64_tr_b16 a[238:239], v4 offset:36768
    s_waitcnt lgkmcnt(8)
    v_mfma_f32_32x32x16_bf16 v[64:79], a[248:251], v[180:183], v[64:79]
    s_add_u32 s60, s60, 14336
    s_add_u32 m0, s55, 31360
    s_nop 0
    buffer_load_dwordx4 v9, s[40:43], s60 offen lds
    ds_read_b64_tr_b16 a[240:241], v4 offset:35904
    ds_read_b64_tr_b16 a[242:243], v4 offset:36800
    v_mfma_f32_32x32x16_bf16 v[80:95], a[252:255], v[180:183], v[80:95]
    ds_read_b64_tr_b16 a[244:245], v4 offset:35936
    ds_read_b64_tr_b16 a[246:247], v4 offset:36832
    s_waitcnt lgkmcnt(8)
    v_mfma_f32_32x32x16_bf16 v[96:111], a[224:227], v[180:183], v[96:111]
    s_add_u32 s60, s60, 14336
    s_add_u32 m0, s55, 32256
    s_nop 0
    buffer_load_dwordx4 v9, s[40:43], s60 offen lds
    ds_read_b64_tr_b16 a[248:249], v4 offset:35968
    ds_read_b64_tr_b16 a[250:251], v4 offset:36864
    v_mfma_f32_32x32x16_bf16 v[112:127], a[228:231], v[180:183], v[112:127]
    ds_read_b64_tr_b16 a[252:253], v4 offset:36000
    ds_read_b64_tr_b16 a[254:255], v4 offset:36896
    s_waitcnt lgkmcnt(8)
    v_mfma_f32_32x32x16_bf16 v[16:31], a[232:235], v[184:187], v[16:31]
    s_add_u32 s60, s60, 14336
    s_add_u32 m0, s55, 33152
    s_nop 0
    buffer_load_dwordx4 v9, s[40:43], s60 offen lds
    ds_read_b64_tr_b16 a[224:225], v4 offset:36032
    ds_read_b64_tr_b16 a[226:227], v4 offset:36928
    v_mfma_f32_32x32x16_bf16 v[32:47], a[236:239], v[184:187], v[32:47]
    ds_read_b64_tr_b16 a[228:229], v4 offset:39424
    ds_read_b64_tr_b16 a[230:231], v12 offset:40320
    s_waitcnt lgkmcnt(8)
    v_mfma_f32_32x32x16_bf16 v[48:63], a[240:243], v[184:187], v[48:63]
    s_add_u32 s60, s60, 14336
    s_add_u32 m0, s55, 34048
    s_mov_b32 exec_hi, s98
    buffer_load_dwordx4 v9, s[40:43], s60 offen lds
    s_mov_b32 exec_hi, -1
    ds_read_b64_tr_b16 a[232:233], v4 offset:39456
    ds_read_b64_tr_b16 a[234:235], v12 offset:40352
    v_mfma_f32_32x32x16_bf16 v[64:79], a[244:247], v[184:187], v[64:79]
    ds_read_b64_tr_b16 a[236:237], v4 offset:39488
    ds_read_b64_tr_b16 a[238:239], v12 offset:40384
    s_waitcnt lgkmcnt(8)
    v_mfma_f32_32x32x16_bf16 v[80:95], a[248:251], v[184:187], v[80:95]
    s_add_u32 s60, s60, 14336
    s_add_u32 m0, s57, 28672
    s_mov_b32 exec_hi, s98
    buffer_load_dwordx4 v9, s[40:43], s60 offen lds
    s_mov_b32 exec_hi, -1
    ds_read_b64_tr_b16 a[240:241], v4 offset:39520
    ds_read_b64_tr_b16 a[242:243], v12 offset:40416
    v_mfma_f32_32x32x16_bf16 v[96:111], a[252:255], v[184:187], v[96:111]
    ds_read_b64_tr_b16 a[244:245], v4 offset:39552
    ds_read_b64_tr_b16 a[246:247], v12 offset:40448
    s_waitcnt lgkmcnt(8)
    v_mfma_f32_32x32x16_bf16 v[112:127], a[224:227], v[184:187], v[112:127]
    ds_read_b64_tr_b16 a[248:249], v4 offset:39584
    ds_read_b64_tr_b16 a[250:251], v12 offset:40480
    v_mfma_f32_32x32x16_bf16 v[16:31], a[228:231], v[188:191], v[16:31]
    ds_read_b64_tr_b16 a[252:253], v4 offset:39616
    ds_read_b64_tr_b16 a[254:255], v12 offset:40512
    s_waitcnt lgkmcnt(8)
    v_mfma_f32_32x32x16_bf16 v[32:47], a[232:235], v[188:191], v[32:47]
    s_waitcnt vmcnt(20)
    s_barrier
    ds_read_b64_tr_b16 a[224:225], v10 offset:0
    ds_read_b64_tr_b16 a[226:227], v10 offset:896
    v_mfma_f32_32x32x16_bf16 v[48:63], a[236:239], v[188:191], v[48:63]
    ds_read_b64_tr_b16 a[228:229], v10 offset:32
    ds_read_b64_tr_b16 a[230:231], v10 offset:928
    s_waitcnt lgkmcnt(8)
    v_mfma_f32_32x32x16_bf16 v[64:79], a[240:243], v[188:191], v[64:79]
    s_lshl_b32 s53, s78, 12
    s_add_u32 s53, s53, s52
    buffer_load_dwordx4 v[224:227], v2, s[36:39], s53 offen offset:0 sc1
    ds_read_b64_tr_b16 a[232:233], v10 offset:64
    ds_read_b64_tr_b16 a[234:235], v10 offset:960
    v_mfma_f32_32x32x16_bf16 v[80:95], a[244:247], v[188:191], v[80:95]
    ds_read_b64_tr_b16 a[236:237], v10 offset:96
    ds_read_b64_tr_b16 a[238:239], v10 offset:992
    s_waitcnt lgkmcnt(8)
    v_mfma_f32_32x32x16_bf16 v[96:111], a[248:251], v[188:191], v[96:111]
    buffer_load_dwordx4 v[228:231], v2, s[36:39], s53 offen offset:1024 sc1
    ds_read_b64_tr_b16 a[240:241], v10 offset:128
    ds_read_b64_tr_b16 a[242:243], v10 offset:1024
    v_mfma_f32_32x32x16_bf16 v[112:127], a[252:255], v[188:191], v[112:127]
    ds_read_b64_tr_b16 a[244:245], v10 offset:160
    ds_read_b64_tr_b16 a[246:247], v10 offset:1056
    s_waitcnt lgkmcnt(8)
    v_mfma_f32_32x32x16_bf16 v[16:31], a[224:227], v[192:195], v[16:31]
    buffer_load_dwordx4 v[232:235], v2, s[36:39], s53 offen offset:2048 sc1
    ds_read_b64_tr_b16 a[248:249], v10 offset:192
    ds_read_b64_tr_b16 a[250:251], v10 offset:1088
    v_mfma_f32_32x32x16_bf16 v[32:47], a[228:231], v[192:195], v[32:47]
    ds_read_b64_tr_b16 a[252:253], v10 offset:3584
    ds_read_b64_tr_b16 a[254:255], v10 offset:4480
    s_waitcnt lgkmcnt(8)
    v_mfma_f32_32x32x16_bf16 v[48:63], a[232:235], v[192:195], v[48:63]
    buffer_load_dwordx4 v[236:239], v2, s[36:39], s53 offen offset:3072 sc1
    ds_read_b64_tr_b16 a[224:225], v10 offset:3616
    ds_read_b64_tr_b16 a[226:227], v10 offset:4512
    v_mfma_f32_32x32x16_bf16 v[64:79], a[236:239], v[192:195], v[64:79]
    ds_read_b64_tr_b16 a[228:229], v10 offset:3648
    ds_read_b64_tr_b16 a[230:231], v10 offset:4544
    s_waitcnt lgkmcnt(8)
    v_mfma_f32_32x32x16_bf16 v[80:95], a[240:243], v[192:195], v[80:95]
    s_mul_i32 s60, s79, 229376
    s_add_u32 s60, s60, s54
    s_add_u32 m0, s55, 57344
    s_nop 0
    buffer_load_dwordx4 v9, s[40:43], s60 offen lds
    ds_read_b64_tr_b16 a[232:233], v10 offset:3680
    ds_read_b64_tr_b16 a[234:235], v10 offset:4576
    v_mfma_f32_32x32x16_bf16 v[96:111], a[244:247], v[192:195], v[96:111]
    ds_read_b64_tr_b16 a[236:237], v10 offset:3712
    ds_read_b64_tr_b16 a[238:239], v10 offset:4608
    s_waitcnt lgkmcnt(8)
    v_mfma_f32_32x32x16_bf16 v[112:127], a[248:251], v[192:195], v[112:127]
    s_add_u32 s60, s60, 14336
    s_add_u32 m0, s55, 58240
    s_nop 0
    buffer_load_dwordx4 v9, s[40:43], s60 offen lds
    ds_read_b64_tr_b16 a[240:241], v10 offset:3744
    ds_read_b64_tr_b16 a[242:243], v10 offset:4640
    v_mfma_f32_32x32x16_bf16 v[16:31], a[252:255], v[196:199], v[16:31]
    ds_read_b64_tr_b16 a[244:245], v10 offset:3776
    ds_read_b64_tr_b16 a[246:247], v10 offset:4672
    s_waitcnt lgkmcnt(8)
    v_mfma_f32_32x32x16_bf16 v[32:47], a[224:227], v[196:199], v[32:47]
    s_add_u32 s60, s60, 14336
    s_add_u32 m0, s55, 59136
    s_nop 0
    buffer_load_dwordx4 v9, s[40:43], s60 offen lds
    ds_read_b64_tr_b16 a[248:249], v10 offset:7168
    ds_read_b64_tr_b16 a[250:251], v10 offset:8064
    v_mfma_f32_32x32x16_bf16 v[48:63], a[228:231], v[196:199], v[48:63]
    ds_read_b64_tr_b16 a[252:253], v10 offset:7200
    ds_read_b64_tr_b16 a[254:255], v10 offset:8096
    s_waitcnt lgkmcnt(8)
    v_mfma_f32_32x32x16_bf16 v[64:79], a[232:235], v[196:199], v[64:79]
    s_add_u32 s60, s60, 14336
    s_add_u32 m0, s55, 60032
    s_nop 0
    buffer_load_dwordx4 v9, s[40:43], s60 offen lds
    ds_read_b64_tr_b16 a[224:225], v10 offset:7232
    ds_read_b64_tr_b16 a[226:227], v10 offset:8128
    v_mfma_f32_32x32x16_bf16 v[80:95], a[236:239], v[196:199], v[80:95]
    ds_read_b64_tr_b16 a[228:229], v10 offset:7264
    ds_read_b64_tr_b16 a[230:231], v10 offset:8160
    s_waitcnt lgkmcnt(8)
    v_mfma_f32_32x32x16_bf16 v[96:111], a[240:243], v[196:199], v[96:111]
    s_add_u32 s60, s60, 14336
    s_add_u32 m0, s55, 60928
    s_nop 0
    buffer_load_dwordx4 v9, s[40:43], s60 offen lds
    ds_read_b64_tr_b16 a[232:233], v10 offset:7296
    ds_read_b64_tr_b16 a[234:235], v10 offset:8192
    v_mfma_f32_32x32x16_bf16 v[112:127], a[244:247], v[196:199], v[112:127]
    ds_read_b64_tr_b16 a[236:237], v10 offset:7328
    ds_read_b64_tr_b16 a[238:239], v10 offset:8224
    s_waitcnt lgkmcnt(8)
    v_mfma_f32_32x32x16_bf16 v[16:31], a[248:251], v[200:203], v[16:31]
    s_add_u32 s60, s60, 14336
    s_add_u32 m0, s55, 61824
    s_nop 0
    buffer_load_dwordx4 v9, s[40:43], s60 offen lds
    ds_read_b64_tr_b16 a[240:241], v10 offset:7360
    ds_read_b64_tr_b16 a[242:243], v10 offset:8256
    v_mfma_f32_32x32x16_bf16 v[32:47], a[252:255], v[200:203], v[32:47]
    ds_read_b64_tr_b16 a[244:245], v10 offset:10752
    ds_read_b64_tr_b16 a[246:247], v14 offset:11648
    s_waitcnt lgkmcnt(8)
    v_mfma_f32_32x32x16_bf16 v[48:63], a[224:227], v[200:203], v[48:63]
    s_add_u32 s60, s60, 14336
    s_add_u32 m0, s55, 62720
    s_mov_b32 exec_hi, s98
    buffer_load_dwordx4 v9, s[40:43], s60 offen lds
    s_mov_b32 exec_hi, -1
    ds_read_b64_tr_b16 a[248:249], v10 offset:10784
    ds_read_b64_tr_b16 a[250:251], v14 offset:11680
    v_mfma_f32_32x32x16_bf16 v[64:79], a[228:231], v[200:203], v[64:79]
    ds_read_b64_tr_b16 a[252:253], v10 offset:10816
    ds_read_b64_tr_b16 a[254:255], v14 offset:11712
    s_waitcnt lgkmcnt(8)
    v_mfma_f32_32x32x16_bf16 v[80:95], a[232:235], v[200:203], v[80:95]
    s_add_u32 s60, s60, 14336
    s_add_u32 m0, s57, 57344
    s_mov_b32 exec_hi, s98
    buffer_load_dwordx4 v9, s[40:43], s60 offen lds
    s_mov_b32 exec_hi, -1
    ds_read_b64_tr_b16 a[224:225], v10 offset:10848
    ds_read_b64_tr_b16 a[226:227], v14 offset:11744
    v_mfma_f32_32x32x16_bf16 v[96:111], a[236:239], v[200:203], v[96:111]
    ds_read_b64_tr_b16 a[228:229], v10 offset:10880
    ds_read_b64_tr_b16 a[230:231], v14 offset:11776
    s_waitcnt lgkmcnt(8)
    v_mfma_f32_32x32x16_bf16 v[112:127], a[240:243], v[200:203], v[112:127]
    ds_read_b64_tr_b16 a[232:233], v10 offset:10912
    ds_read_b64_tr_b16 a[234:235], v14 offset:11808
    v_mfma_f32_32x32x16_bf16 v[16:31], a[244:247], v[204:207], v[16:31]
    ds_read_b64_tr_b16 a[236:237], v10 offset:10944
    ds_read_b64_tr_b16 a[238:239], v14 offset:11840
    s_waitcnt lgkmcnt(8)
    v_mfma_f32_32x32x16_bf16 v[32:47], a[248:251], v[204:207], v[32:47]
    s_waitcnt vmcnt(20)
    s_barrier
    ds_read_b64_tr_b16 a[240:241], v3 offset:0
    ds_read_b64_tr_b16 a[242:243], v3 offset:896
    v_mfma_f32_32x32x16_bf16 v[48:63], a[252:255], v[204:207], v[48:63]
    ds_read_b64_tr_b16 a[244:245], v3 offset:32
    ds_read_b64_tr_b16 a[246:247], v3 offset:928
    s_waitcnt lgkmcnt(8)
    v_mfma_f32_32x32x16_bf16 v[64:79], a[224:227], v[204:207], v[64:79]
    s_lshl_b32 s53, s79, 12
    s_add_u32 s53, s53, s52
    buffer_load_dwordx4 v[240:243], v2, s[36:39], s53 offen offset:0 sc1
    ds_read_b64_tr_b16 a[248:249], v3 offset:64
    ds_read_b64_tr_b16 a[250:251], v3 offset:960
    v_mfma_f32_32x32x16_bf16 v[80:95], a[228:231], v[204:207], v[80:95]
    ds_read_b64_tr_b16 a[252:253], v3 offset:96
    ds_read_b64_tr_b16 a[254:255], v3 offset:992
    s_waitcnt lgkmcnt(8)
    v_mfma_f32_32x32x16_bf16 v[96:111], a[232:235], v[204:207], v[96:111]
    ds_read_b64_tr_b16 a[224:225], v3 offset:128
    ds_read_b64_tr_b16 a[226:227], v3 offset:1024
    v_mfma_f32_32x32x16_bf16 v[112:127], a[236:239], v[204:207], v[112:127]
    ds_read_b64_tr_b16 a[228:229], v3 offset:160
    ds_read_b64_tr_b16 a[230:231], v3 offset:1056
    s_waitcnt lgkmcnt(8)
    v_mfma_f32_32x32x16_bf16 v[16:31], a[240:243], v[208:211], v[16:31]
    ds_read_b64_tr_b16 a[232:233], v3 offset:192
    ds_read_b64_tr_b16 a[234:235], v3 offset:1088
    v_mfma_f32_32x32x16_bf16 v[32:47], a[244:247], v[208:211], v[32:47]
    ds_read_b64_tr_b16 a[236:237], v3 offset:3584
    ds_read_b64_tr_b16 a[238:239], v3 offset:4480
    s_waitcnt lgkmcnt(8)
    v_mfma_f32_32x32x16_bf16 v[48:63], a[248:251], v[208:211], v[48:63]
    buffer_load_dwordx4 v[244:247], v2, s[36:39], s53 offen offset:1024 sc1
    ds_read_b64_tr_b16 a[240:241], v3 offset:3616
    ds_read_b64_tr_b16 a[242:243], v3 offset:4512
    v_mfma_f32_32x32x16_bf16 v[64:79], a[252:255], v[208:211], v[64:79]
    ds_read_b64_tr_b16 a[244:245], v3 offset:3648
    ds_read_b64_tr_b16 a[246:247], v3 offset:4544
    s_waitcnt lgkmcnt(8)
    v_mfma_f32_32x32x16_bf16 v[80:95], a[224:227], v[208:211], v[80:95]
    ds_read_b64_tr_b16 a[248:249], v3 offset:3680
    ds_read_b64_tr_b16 a[250:251], v3 offset:4576
    v_mfma_f32_32x32x16_bf16 v[96:111], a[228:231], v[208:211], v[96:111]
    ds_read_b64_tr_b16 a[252:253], v3 offset:3712
    ds_read_b64_tr_b16 a[254:255], v3 offset:4608
    s_waitcnt lgkmcnt(8)
    v_mfma_f32_32x32x16_bf16 v[112:127], a[232:235], v[208:211], v[112:127]
    ds_read_b64_tr_b16 a[224:225], v3 offset:3744
    ds_read_b64_tr_b16 a[226:227], v3 offset:4640
    v_mfma_f32_32x32x16_bf16 v[16:31], a[236:239], v[212:215], v[16:31]
    ds_read_b64_tr_b16 a[228:229], v3 offset:3776
    ds_read_b64_tr_b16 a[230:231], v3 offset:4672
    s_waitcnt lgkmcnt(8)
    v_mfma_f32_32x32x16_bf16 v[32:47], a[240:243], v[212:215], v[32:47]
    buffer_load_dwordx4 v[248:251], v2, s[36:39], s53 offen offset:2048 sc1
    ds_read_b64_tr_b16 a[232:233], v3 offset:7168
    ds_read_b64_tr_b16 a[234:235], v3 offset:8064
    v_mfma_f32_32x32x16_bf16 v[48:63], a[244:247], v[212:215], v[48:63]
    ds_read_b64_tr_b16 a[236:237], v3 offset:7200
    ds_read_b64_tr_b16 a[238:239], v3 offset:8096
    s_waitcnt lgkmcnt(8)
    v_mfma_f32_32x32x16_bf16 v[64:79], a[248:251], v[212:215], v[64:79]
    ds_read_b64_tr_b16 a[240:241], v3 offset:7232
    ds_read_b64_tr_b16 a[242:243], v3 offset:8128
    v_mfma_f32_32x32x16_bf16 v[80:95], a[252:255], v[212:215], v[80:95]
    ds_read_b64_tr_b16 a[244:245], v3 offset:7264
    ds_read_b64_tr_b16 a[246:247], v3 offset:8160
    s_waitcnt lgkmcnt(8)
    v_mfma_f32_32x32x16_bf16 v[96:111], a[224:227], v[212:215], v[96:111]
    ds_read_b64_tr_b16 a[248:249], v3 offset:7296
    ds_read_b64_tr_b16 a[250:251], v3 offset:8192
    v_mfma_f32_32x32x16_bf16 v[112:127], a[228:231], v[212:215], v[112:127]
    ds_read_b64_tr_b16 a[252:253], v3 offset:7328
    ds_read_b64_tr_b16 a[254:255], v3 offset:8224
    s_waitcnt lgkmcnt(8)
    v_mfma_f32_32x32x16_bf16 v[16:31], a[232:235], v[216:219], v[16:31]
    buffer_load_dwordx4 v[252:255], v2, s[36:39], s53 offen offset:3072 sc1
    ds_read_b64_tr_b16 a[224:225], v3 offset:7360
    ds_read_b64_tr_b16 a[226:227], v3 offset:8256
    v_mfma_f32_32x32x16_bf16 v[32:47], a[236:239], v[216:219], v[32:47]
    ds_read_b64_tr_b16 a[228:229], v3 offset:10752
    ds_read_b64_tr_b16 a[230:231], v11 offset:11648
    s_waitcnt lgkmcnt(8)
    v_mfma_f32_32x32x16_bf16 v[48:63], a[240:243], v[216:219], v[48:63]
    ds_read_b64_tr_b16 a[232:233], v3 offset:10784
    ds_read_b64_tr_b16 a[234:235], v11 offset:11680
    v_mfma_f32_32x32x16_bf16 v[64:79], a[244:247], v[216:219], v[64:79]
    ds_read_b64_tr_b16 a[236:237], v3 offset:10816
    ds_read_b64_tr_b16 a[238:239], v11 offset:11712
    s_waitcnt lgkmcnt(8)
    v_mfma_f32_32x32x16_bf16 v[80:95], a[248:251], v[216:219], v[80:95]
    ds_read_b64_tr_b16 a[240:241], v3 offset:10848
    ds_read_b64_tr_b16 a[242:243], v11 offset:11744
    v_mfma_f32_32x32x16_bf16 v[96:111], a[252:255], v[216:219], v[96:111]
    ds_read_b64_tr_b16 a[244:245], v3 offset:10880
    ds_read_b64_tr_b16 a[246:247], v11 offset:11776
    s_waitcnt lgkmcnt(8)
    v_mfma_f32_32x32x16_bf16 v[112:127], a[224:227], v[216:219], v[112:127]
    ds_read_b64_tr_b16 a[248:249], v3 offset:10912
    ds_read_b64_tr_b16 a[250:251], v11 offset:11808
    v_mfma_f32_32x32x16_bf16 v[16:31], a[228:231], v[220:223], v[16:31]
    ds_read_b64_tr_b16 a[252:253], v3 offset:10944
    ds_read_b64_tr_b16 a[254:255], v11 offset:11840
    s_waitcnt lgkmcnt(8)
    v_mfma_f32_32x32x16_bf16 v[32:47], a[232:235], v[220:223], v[32:47]
    s_waitcnt vmcnt(12)
    s_barrier
    ds_read_b64_tr_b16 a[224:225], v3 offset:28672
    ds_read_b64_tr_b16 a[226:227], v3 offset:29568
    v_mfma_f32_32x32x16_bf16 v[48:63], a[236:239], v[220:223], v[48:63]
    ds_read_b64_tr_b16 a[228:229], v3 offset:28704
    ds_read_b64_tr_b16 a[230:231], v3 offset:29600
    s_waitcnt lgkmcnt(8)
    v_mfma_f32_32x32x16_bf16 v[64:79], a[240:243], v[220:223], v[64:79]
    ds_read_b64_tr_b16 a[232:233], v3 offset:28736
    ds_read_b64_tr_b16 a[234:235], v3 offset:29632
    v_mfma_f32_32x32x16_bf16 v[80:95], a[244:247], v[220:223], v[80:95]
    ds_read_b64_tr_b16 a[236:237], v3 offset:28768
    ds_read_b64_tr_b16 a[238:239], v3 offset:29664
    s_waitcnt lgkmcnt(8)
    v_mfma_f32_32x32x16_bf16 v[96:111], a[248:251], v[220:223], v[96:111]
    ds_read_b64_tr_b16 a[240:241], v3 offset:28800
    ds_read_b64_tr_b16 a[242:243], v3 offset:29696
    v_mfma_f32_32x32x16_bf16 v[112:127], a[252:255], v[220:223], v[112:127]
    ds_read_b64_tr_b16 a[244:245], v3 offset:28832
    ds_read_b64_tr_b16 a[246:247], v3 offset:29728
    s_waitcnt lgkmcnt(8)
    v_mfma_f32_32x32x16_bf16 v[16:31], a[224:227], v[224:227], v[16:31]
    ds_read_b64_tr_b16 a[248:249], v3 offset:28864
    ds_read_b64_tr_b16 a[250:251], v3 offset:29760
    v_mfma_f32_32x32x16_bf16 v[32:47], a[228:231], v[224:227], v[32:47]
    ds_read_b64_tr_b16 a[252:253], v3 offset:32256
    ds_read_b64_tr_b16 a[254:255], v3 offset:33152
    s_waitcnt lgkmcnt(8)
    v_mfma_f32_32x32x16_bf16 v[48:63], a[232:235], v[224:227], v[48:63]
    ds_read_b64_tr_b16 a[224:225], v3 offset:32288
    ds_read_b64_tr_b16 a[226:227], v3 offset:33184
    v_mfma_f32_32x32x16_bf16 v[64:79], a[236:239], v[224:227], v[64:79]
    ds_read_b64_tr_b16 a[228:229], v3 offset:32320
    ds_read_b64_tr_b16 a[230:231], v3 offset:33216
    s_waitcnt lgkmcnt(8)
    v_mfma_f32_32x32x16_bf16 v[80:95], a[240:243], v[224:227], v[80:95]
    ds_read_b64_tr_b16 a[232:233], v3 offset:32352
    ds_read_b64_tr_b16 a[234:235], v3 offset:33248
    v_mfma_f32_32x32x16_bf16 v[96:111], a[244:247], v[224:227], v[96:111]
    ds_read_b64_tr_b16 a[236:237], v3 offset:32384
    ds_read_b64_tr_b16 a[238:239], v3 offset:33280
    s_waitcnt lgkmcnt(8)
    v_mfma_f32_32x32x16_bf16 v[112:127], a[248:251], v[224:227], v[112:127]
    ds_read_b64_tr_b16 a[240:241], v3 offset:32416
    ds_read_b64_tr_b16 a[242:243], v3 offset:33312
    v_mfma_f32_32x32x16_bf16 v[16:31], a[252:255], v[228:231], v[16:31]
    ds_read_b64_tr_b16 a[244:245], v3 offset:32448
    ds_read_b64_tr_b16 a[246:247], v3 offset:33344
    s_waitcnt lgkmcnt(8)
    v_mfma_f32_32x32x16_bf16 v[32:47], a[224:227], v[228:231], v[32:47]
    ds_read_b64_tr_b16 a[248:249], v3 offset:35840
    ds_read_b64_tr_b16 a[250:251], v3 offset:36736
    v_mfma_f32_32x32x16_bf16 v[48:63], a[228:231], v[228:231], v[48:63]
    ds_read_b64_tr_b16 a[252:253], v3 offset:35872
    ds_read_b64_tr_b16 a[254:255], v3 offset:36768
    s_waitcnt lgkmcnt(8)
    v_mfma_f32_32x32x16_bf16 v[64:79], a[232:235], v[228:231], v[64:79]
    ds_read_b64_tr_b16 a[224:225], v3 offset:35904
    ds_read_b64_tr_b16 a[226:227], v3 offset:36800
    v_mfma_f32_32x32x16_bf16 v[80:95], a[236:239], v[228:231], v[80:95]
    ds_read_b64_tr_b16 a[228:229], v3 offset:35936
    ds_read_b64_tr_b16 a[230:231], v3 offset:36832
    s_waitcnt lgkmcnt(8)
    v_mfma_f32_32x32x16_bf16 v[96:111], a[240:243], v[228:231], v[96:111]
    ds_read_b64_tr_b16 a[232:233], v3 offset:35968
    ds_read_b64_tr_b16 a[234:235], v3 offset:36864
    v_mfma_f32_32x32x16_bf16 v[112:127], a[244:247], v[228:231], v[112:127]
    ds_read_b64_tr_b16 a[236:237], v3 offset:36000
    ds_read_b64_tr_b16 a[238:239], v3 offset:36896
    s_waitcnt lgkmcnt(8)
    v_mfma_f32_32x32x16_bf16 v[16:31], a[248:251], v[232:235], v[16:31]
    ds_read_b64_tr_b16 a[240:241], v3 offset:36032
    ds_read_b64_tr_b16 a[242:243], v3 offset:36928
    v_mfma_f32_32x32x16_bf16 v[32:47], a[252:255], v[232:235], v[32:47]
    ds_read_b64_tr_b16 a[244:245], v3 offset:39424
    ds_read_b64_tr_b16 a[246:247], v11 offset:40320
    s_waitcnt lgkmcnt(8)
    v_mfma_f32_32x32x16_bf16 v[48:63], a[224:227], v[232:235], v[48:63]
    ds_read_b64_tr_b16 a[248:249], v3 offset:39456
    ds_read_b64_tr_b16 a[250:251], v11 offset:40352
    v_mfma_f32_32x32x16_bf16 v[64:79], a[228:231], v[232:235], v[64:79]
    ds_read_b64_tr_b16 a[252:253], v3 offset:39488
    ds_read_b64_tr_b16 a[254:255], v11 offset:40384
    s_waitcnt lgkmcnt(8)
    v_mfma_f32_32x32x16_bf16 v[80:95], a[232:235], v[232:235], v[80:95]
    ds_read_b64_tr_b16 a[224:225], v3 offset:39520
    ds_read_b64_tr_b16 a[226:227], v11 offset:40416
    v_mfma_f32_32x32x16_bf16 v[96:111], a[236:239], v[232:235], v[96:111]
    ds_read_b64_tr_b16 a[228:229], v3 offset:39552
    ds_read_b64_tr_b16 a[230:231], v11 offset:40448
    s_waitcnt lgkmcnt(8)
    v_mfma_f32_32x32x16_bf16 v[112:127], a[240:243], v[232:235], v[112:127]
    ds_read_b64_tr_b16 a[232:233], v3 offset:39584
    ds_read_b64_tr_b16 a[234:235], v11 offset:40480
    v_mfma_f32_32x32x16_bf16 v[16:31], a[244:247], v[236:239], v[16:31]
    ds_read_b64_tr_b16 a[236:237], v3 offset:39616
    ds_read_b64_tr_b16 a[238:239], v11 offset:40512
    s_waitcnt lgkmcnt(8)
    v_mfma_f32_32x32x16_bf16 v[32:47], a[248:251], v[236:239], v[32:47]
    s_waitcnt vmcnt(0)
    s_barrier
    ds_read_b64_tr_b16 a[240:241], v4 offset:0
    ds_read_b64_tr_b16 a[242:243], v4 offset:896
    v_mfma_f32_32x32x16_bf16 v[48:63], a[252:255], v[236:239], v[48:63]
    ds_read_b64_tr_b16 a[244:245], v4 offset:32
    ds_read_b64_tr_b16 a[246:247], v4 offset:928
    s_waitcnt lgkmcnt(8)
    v_mfma_f32_32x32x16_bf16 v[64:79], a[224:227], v[236:239], v[64:79]
    ds_read_b64_tr_b16 a[248:249], v4 offset:64
    ds_read_b64_tr_b16 a[250:251], v4 offset:960
    v_mfma_f32_32x32x16_bf16 v[80:95], a[228:231], v[236:239], v[80:95]
    ds_read_b64_tr_b16 a[252:253], v4 offset:96
    ds_read_b64_tr_b16 a[254:255], v4 offset:992
    s_waitcnt lgkmcnt(8)
    v_mfma_f32_32x32x16_bf16 v[96:111], a[232:235], v[236:239], v[96:111]
    ds_read_b64_tr_b16 a[224:225], v4 offset:128
    ds_read_b64_tr_b16 a[226:227], v4 offset:1024
    v_mfma_f32_32x32x16_bf16 v[112:127], a[236:239], v[236:239], v[112:127]
    ds_read_b64_tr_b16 a[228:229], v4 offset:160
    ds_read_b64_tr_b16 a[230:231], v4 offset:1056
    s_waitcnt lgkmcnt(8)
    v_mfma_f32_32x32x16_bf16 v[16:31], a[240:243], v[240:243], v[16:31]
    ds_read_b64_tr_b16 a[232:233], v4 offset:192
    ds_read_b64_tr_b16 a[234:235], v4 offset:1088
    v_mfma_f32_32x32x16_bf16 v[32:47], a[244:247], v[240:243], v[32:47]
    ds_read_b64_tr_b16 a[236:237], v4 offset:3584
    ds_read_b64_tr_b16 a[238:239], v4 offset:4480
    s_waitcnt lgkmcnt(8)
    v_mfma_f32_32x32x16_bf16 v[48:63], a[248:251], v[240:243], v[48:63]
    ds_read_b64_tr_b16 a[240:241], v4 offset:3616
    ds_read_b64_tr_b16 a[242:243], v4 offset:4512
    v_mfma_f32_32x32x16_bf16 v[64:79], a[252:255], v[240:243], v[64:79]
    ds_read_b64_tr_b16 a[244:245], v4 offset:3648
    ds_read_b64_tr_b16 a[246:247], v4 offset:4544
    s_waitcnt lgkmcnt(8)
    v_mfma_f32_32x32x16_bf16 v[80:95], a[224:227], v[240:243], v[80:95]
    ds_read_b64_tr_b16 a[248:249], v4 offset:3680
    ds_read_b64_tr_b16 a[250:251], v4 offset:4576
    v_mfma_f32_32x32x16_bf16 v[96:111], a[228:231], v[240:243], v[96:111]
    ds_read_b64_tr_b16 a[252:253], v4 offset:3712
    ds_read_b64_tr_b16 a[254:255], v4 offset:4608
    s_waitcnt lgkmcnt(8)
    v_mfma_f32_32x32x16_bf16 v[112:127], a[232:235], v[240:243], v[112:127]
    ds_read_b64_tr_b16 a[224:225], v4 offset:3744
    ds_read_b64_tr_b16 a[226:227], v4 offset:4640
    v_mfma_f32_32x32x16_bf16 v[16:31], a[236:239], v[244:247], v[16:31]
    ds_read_b64_tr_b16 a[228:229], v4 offset:3776
    ds_read_b64_tr_b16 a[230:231], v4 offset:4672
    s_waitcnt lgkmcnt(8)
    v_mfma_f32_32x32x16_bf16 v[32:47], a[240:243], v[244:247], v[32:47]
    ds_read_b64_tr_b16 a[232:233], v4 offset:7168
    ds_read_b64_tr_b16 a[234:235], v4 offset:8064
    v_mfma_f32_32x32x16_bf16 v[48:63], a[244:247], v[244:247], v[48:63]
    ds_read_b64_tr_b16 a[236:237], v4 offset:7200
    ds_read_b64_tr_b16 a[238:239], v4 offset:8096
    s_waitcnt lgkmcnt(8)
    v_mfma_f32_32x32x16_bf16 v[64:79], a[248:251], v[244:247], v[64:79]
    ds_read_b64_tr_b16 a[240:241], v4 offset:7232
    ds_read_b64_tr_b16 a[242:243], v4 offset:8128
    v_mfma_f32_32x32x16_bf16 v[80:95], a[252:255], v[244:247], v[80:95]
    ds_read_b64_tr_b16 a[244:245], v4 offset:7264
    ds_read_b64_tr_b16 a[246:247], v4 offset:8160
    s_waitcnt lgkmcnt(8)
    v_mfma_f32_32x32x16_bf16 v[96:111], a[224:227], v[244:247], v[96:111]
    ds_read_b64_tr_b16 a[248:249], v4 offset:7296
    ds_read_b64_tr_b16 a[250:251], v4 offset:8192
    v_mfma_f32_32x32x16_bf16 v[112:127], a[228:231], v[244:247], v[112:127]
    ds_read_b64_tr_b16 a[252:253], v4 offset:7328
    ds_read_b64_tr_b16 a[254:255], v4 offset:8224
    s_waitcnt lgkmcnt(8)
    v_mfma_f32_32x32x16_bf16 v[16:31], a[232:235], v[248:251], v[16:31]
    ds_read_b64_tr_b16 a[224:225], v4 offset:7360
    ds_read_b64_tr_b16 a[226:227], v4 offset:8256
    v_mfma_f32_32x32x16_bf16 v[32:47], a[236:239], v[248:251], v[32:47]
    ds_read_b64_tr_b16 a[228:229], v4 offset:10752
    ds_read_b64_tr_b16 a[230:231], v12 offset:11648
    s_waitcnt lgkmcnt(8)
    v_mfma_f32_32x32x16_bf16 v[48:63], a[240:243], v[248:251], v[48:63]
    ds_read_b64_tr_b16 a[232:233], v4 offset:10784
    ds_read_b64_tr_b16 a[234:235], v12 offset:11680
    v_mfma_f32_32x32x16_bf16 v[64:79], a[244:247], v[248:251], v[64:79]
    ds_read_b64_tr_b16 a[236:237], v4 offset:10816
    ds_read_b64_tr_b16 a[238:239], v12 offset:11712
    s_waitcnt lgkmcnt(8)
    v_mfma_f32_32x32x16_bf16 v[80:95], a[248:251], v[248:251], v[80:95]
    ds_read_b64_tr_b16 a[240:241], v4 offset:10848
    ds_read_b64_tr_b16 a[242:243], v12 offset:11744
    v_mfma_f32_32x32x16_bf16 v[96:111], a[252:255], v[248:251], v[96:111]
    ds_read_b64_tr_b16 a[244:245], v4 offset:10880
    ds_read_b64_tr_b16 a[246:247], v12 offset:11776
    s_waitcnt lgkmcnt(8)
    v_mfma_f32_32x32x16_bf16 v[112:127], a[224:227], v[248:251], v[112:127]
    ds_read_b64_tr_b16 a[248:249], v4 offset:10912
    ds_read_b64_tr_b16 a[250:251], v12 offset:11808
    v_mfma_f32_32x32x16_bf16 v[16:31], a[228:231], v[252:255], v[16:31]
    ds_read_b64_tr_b16 a[252:253], v4 offset:10944
    ds_read_b64_tr_b16 a[254:255], v12 offset:11840
    s_waitcnt lgkmcnt(8)
    v_mfma_f32_32x32x16_bf16 v[32:47], a[232:235], v[252:255], v[32:47]
    v_mfma_f32_32x32x16_bf16 v[48:63], a[236:239], v[252:255], v[48:63]
    s_waitcnt lgkmcnt(4)
    v_mfma_f32_32x32x16_bf16 v[64:79], a[240:243], v[252:255], v[64:79]
    v_mfma_f32_32x32x16_bf16 v[80:95], a[244:247], v[252:255], v[80:95]
    s_waitcnt lgkmcnt(0)
    v_mfma_f32_32x32x16_bf16 v[96:111], a[248:251], v[252:255], v[96:111]
    v_mfma_f32_32x32x16_bf16 v[112:127], a[252:255], v[252:255], v[112:127]

    s_mov_b32 s56, 0xbdd2d3e8
    s_mov_b32 s57, 0xbdd2d3e8
    s_mul_i32 s58, s34, 112
    s_mul_i32 s59, s31, 7
    s_add_u32 s58, s58, s59
    s_lshl_b32 s58, s58, 10
    v_mov_b32 v160, 0xc0135761
    v_mov_b32 v161, 0xc0135761
    v_pk_mul_f32 v[128:129], v[16:17], v[16:17]
    v_pk_mul_f32 v[130:131], v[18:19], v[18:19]
    v_pk_mul_f32 v[132:133], v[20:21], v[20:21]
    v_pk_mul_f32 v[134:135], v[22:23], v[22:23]
    v_pk_fma_f32 v[128:129], v[128:129], s[56:57], v[160:161]
    v_pk_fma_f32 v[130:131], v[130:131], s[56:57], v[160:161]
    v_pk_fma_f32 v[132:133], v[132:133], s[56:57], v[160:161]
    v_pk_fma_f32 v[134:135], v[134:135], s[56:57], v[160:161]
    v_pk_mul_f32 v[128:129], v[128:129], v[16:17]
    v_pk_mul_f32 v[130:131], v[130:131], v[18:19]
    v_pk_mul_f32 v[132:133], v[132:133], v[20:21]
    v_pk_mul_f32 v[134:135], v[134:135], v[22:23]
    v_exp_f32 v128, v128
    v_exp_f32 v129, v129
    v_exp_f32 v130, v130
    v_exp_f32 v131, v131
    v_exp_f32 v132, v132
    v_exp_f32 v133, v133
    v_exp_f32 v134, v134
    v_exp_f32 v135, v135
    v_pk_mul_f32 v[16:17], v[16:17], v[24:25]
    v_pk_mul_f32 v[18:19], v[18:19], v[26:27]
    v_pk_mul_f32 v[20:21], v[20:21], v[28:29]
    v_pk_mul_f32 v[22:23], v[22:23], v[30:31]
    v_pk_add_f32 v[128:129], v[128:129], 1.0 op_sel_hi:[1,0]
    v_pk_add_f32 v[130:131], v[130:131], 1.0 op_sel_hi:[1,0]
    v_pk_add_f32 v[132:133], v[132:133], 1.0 op_sel_hi:[1,0]
    v_pk_add_f32 v[134:135], v[134:135], 1.0 op_sel_hi:[1,0]
    v_rcp_f32 v128, v128
    v_rcp_f32 v129, v129
    v_rcp_f32 v130, v130
    v_rcp_f32 v131, v131
    v_rcp_f32 v132, v132
    v_rcp_f32 v133, v133
    v_rcp_f32 v134, v134
    v_rcp_f32 v135, v135
    v_pk_mul_f32 v[16:17], v[16:17], v[128:129]
    v_pk_mul_f32 v[18:19], v[18:19], v[130:131]
    v_pk_mul_f32 v[20:21], v[20:21], v[132:133]
    v_pk_mul_f32 v[22:23], v[22:23], v[134:135]
    v_cvt_pk_bf16_f32 v136, v16, v17
    v_cvt_pk_bf16_f32 v137, v18, v19
    v_cvt_pk_bf16_f32 v138, v20, v21
    v_cvt_pk_bf16_f32 v139, v22, v23
    buffer_store_dwordx4 v[136:139], v2, s[44:47], s58 offen sc1
    s_add_u32 s58, s58, 1024
    v_pk_mul_f32 v[144:145], v[32:33], v[32:33]
    v_pk_mul_f32 v[146:147], v[34:35], v[34:35]
    v_pk_mul_f32 v[148:149], v[36:37], v[36:37]
    v_pk_mul_f32 v[150:151], v[38:39], v[38:39]
    v_pk_fma_f32 v[144:145], v[144:145], s[56:57], v[160:161]
    v_pk_fma_f32 v[146:147], v[146:147], s[56:57], v[160:161]
    v_pk_fma_f32 v[148:149], v[148:149], s[56:57], v[160:161]
    v_pk_fma_f32 v[150:151], v[150:151], s[56:57], v[160:161]
    v_pk_mul_f32 v[144:145], v[144:145], v[32:33]
    v_pk_mul_f32 v[146:147], v[146:147], v[34:35]
    v_pk_mul_f32 v[148:149], v[148:149], v[36:37]
    v_pk_mul_f32 v[150:151], v[150:151], v[38:39]
    v_exp_f32 v144, v144
    v_exp_f32 v145, v145
    v_exp_f32 v146, v146
    v_exp_f32 v147, v147
    v_exp_f32 v148, v148
    v_exp_f32 v149, v149
    v_exp_f32 v150, v150
    v_exp_f32 v151, v151
    v_pk_mul_f32 v[32:33], v[32:33], v[40:41]
    v_pk_mul_f32 v[34:35], v[34:35], v[42:43]
    v_pk_mul_f32 v[36:37], v[36:37], v[44:45]
    v_pk_mul_f32 v[38:39], v[38:39], v[46:47]
    v_pk_add_f32 v[144:145], v[144:145], 1.0 op_sel_hi:[1,0]
    v_pk_add_f32 v[146:147], v[146:147], 1.0 op_sel_hi:[1,0]
    v_pk_add_f32 v[148:149], v[148:149], 1.0 op_sel_hi:[1,0]
    v_pk_add_f32 v[150:151], v[150:151], 1.0 op_sel_hi:[1,0]
    v_rcp_f32 v144, v144
    v_rcp_f32 v145, v145
    v_rcp_f32 v146, v146
    v_rcp_f32 v147, v147
    v_rcp_f32 v148, v148
    v_rcp_f32 v149, v149
    v_rcp_f32 v150, v150
    v_rcp_f32 v151, v151
    v_pk_mul_f32 v[32:33], v[32:33], v[144:145]
    v_pk_mul_f32 v[34:35], v[34:35], v[146:147]
    v_pk_mul_f32 v[36:37], v[36:37], v[148:149]
    v_pk_mul_f32 v[38:39], v[38:39], v[150:151]
    v_cvt_pk_bf16_f32 v152, v32, v33
    v_cvt_pk_bf16_f32 v153, v34, v35
    v_cvt_pk_bf16_f32 v154, v36, v37
    v_cvt_pk_bf16_f32 v155, v38, v39
    buffer_store_dwordx4 v[152:155], v2, s[44:47], s58 offen sc1
    s_add_u32 s58, s58, 1024
    v_pk_mul_f32 v[128:129], v[48:49], v[48:49]
    v_pk_mul_f32 v[130:131], v[50:51], v[50:51]
    v_pk_mul_f32 v[132:133], v[52:53], v[52:53]
    v_pk_mul_f32 v[134:135], v[54:55], v[54:55]
    v_pk_fma_f32 v[128:129], v[128:129], s[56:57], v[160:161]
    v_pk_fma_f32 v[130:131], v[130:131], s[56:57], v[160:161]
    v_pk_fma_f32 v[132:133], v[132:133], s[56:57], v[160:161]
    v_pk_fma_f32 v[134:135], v[134:135], s[56:57], v[160:161]
    v_pk_mul_f32 v[128:129], v[128:129], v[48:49]
    v_pk_mul_f32 v[130:131], v[130:131], v[50:51]
    v_pk_mul_f32 v[132:133], v[132:133], v[52:53]
    v_pk_mul_f32 v[134:135], v[134:135], v[54:55]
    v_exp_f32 v128, v128
    v_exp_f32 v129, v129
    v_exp_f32 v130, v130
    v_exp_f32 v131, v131
    v_exp_f32 v132, v132
    v_exp_f32 v133, v133
    v_exp_f32 v134, v134
    v_exp_f32 v135, v135
    v_pk_mul_f32 v[48:49], v[48:49], v[56:57]
    v_pk_mul_f32 v[50:51], v[50:51], v[58:59]
    v_pk_mul_f32 v[52:53], v[52:53], v[60:61]
    v_pk_mul_f32 v[54:55], v[54:55], v[62:63]
    v_pk_add_f32 v[128:129], v[128:129], 1.0 op_sel_hi:[1,0]
    v_pk_add_f32 v[130:131], v[130:131], 1.0 op_sel_hi:[1,0]
    v_pk_add_f32 v[132:133], v[132:133], 1.0 op_sel_hi:[1,0]
    v_pk_add_f32 v[134:135], v[134:135], 1.0 op_sel_hi:[1,0]
    v_rcp_f32 v128, v128
    v_rcp_f32 v129, v129
    v_rcp_f32 v130, v130
    v_rcp_f32 v131, v131
    v_rcp_f32 v132, v132
    v_rcp_f32 v133, v133
    v_rcp_f32 v134, v134
    v_rcp_f32 v135, v135
    v_pk_mul_f32 v[48:49], v[48:49], v[128:129]
    v_pk_mul_f32 v[50:51], v[50:51], v[130:131]
    v_pk_mul_f32 v[52:53], v[52:53], v[132:133]
    v_pk_mul_f32 v[54:55], v[54:55], v[134:135]
    v_cvt_pk_bf16_f32 v136, v48, v49
    v_cvt_pk_bf16_f32 v137, v50, v51
    v_cvt_pk_bf16_f32 v138, v52, v53
    v_cvt_pk_bf16_f32 v139, v54, v55
    buffer_store_dwordx4 v[136:139], v2, s[44:47], s58 offen sc1
    s_add_u32 s58, s58, 1024
    v_pk_mul_f32 v[144:145], v[64:65], v[64:65]
    v_pk_mul_f32 v[146:147], v[66:67], v[66:67]
    v_pk_mul_f32 v[148:149], v[68:69], v[68:69]
    v_pk_mul_f32 v[150:151], v[70:71], v[70:71]
    v_pk_fma_f32 v[144:145], v[144:145], s[56:57], v[160:161]
    v_pk_fma_f32 v[146:147], v[146:147], s[56:57], v[160:161]
    v_pk_fma_f32 v[148:149], v[148:149], s[56:57], v[160:161]
    v_pk_fma_f32 v[150:151], v[150:151], s[56:57], v[160:161]
    v_pk_mul_f32 v[144:145], v[144:145], v[64:65]
    v_pk_mul_f32 v[146:147], v[146:147], v[66:67]
    v_pk_mul_f32 v[148:149], v[148:149], v[68:69]
    v_pk_mul_f32 v[150:151], v[150:151], v[70:71]
    v_exp_f32 v144, v144
    v_exp_f32 v145, v145
    v_exp_f32 v146, v146
    v_exp_f32 v147, v147
    v_exp_f32 v148, v148
    v_exp_f32 v149, v149
    v_exp_f32 v150, v150
    v_exp_f32 v151, v151
    v_pk_mul_f32 v[64:65], v[64:65], v[72:73]
    v_pk_mul_f32 v[66:67], v[66:67], v[74:75]
    v_pk_mul_f32 v[68:69], v[68:69], v[76:77]
    v_pk_mul_f32 v[70:71], v[70:71], v[78:79]
    v_pk_add_f32 v[144:145], v[144:145], 1.0 op_sel_hi:[1,0]
    v_pk_add_f32 v[146:147], v[146:147], 1.0 op_sel_hi:[1,0]
    v_pk_add_f32 v[148:149], v[148:149], 1.0 op_sel_hi:[1,0]
    v_pk_add_f32 v[150:151], v[150:151], 1.0 op_sel_hi:[1,0]
    v_rcp_f32 v144, v144
    v_rcp_f32 v145, v145
    v_rcp_f32 v146, v146
    v_rcp_f32 v147, v147
    v_rcp_f32 v148, v148
    v_rcp_f32 v149, v149
    v_rcp_f32 v150, v150
    v_rcp_f32 v151, v151
    v_pk_mul_f32 v[64:65], v[64:65], v[144:145]
    v_pk_mul_f32 v[66:67], v[66:67], v[146:147]
    v_pk_mul_f32 v[68:69], v[68:69], v[148:149]
    v_pk_mul_f32 v[70:71], v[70:71], v[150:151]
    v_cvt_pk_bf16_f32 v152, v64, v65
    v_cvt_pk_bf16_f32 v153, v66, v67
    v_cvt_pk_bf16_f32 v154, v68, v69
    v_cvt_pk_bf16_f32 v155, v70, v71
    buffer_store_dwordx4 v[152:155], v2, s[44:47], s58 offen sc1
    s_add_u32 s58, s58, 1024
    v_pk_mul_f32 v[128:129], v[80:81], v[80:81]
    v_pk_mul_f32 v[130:131], v[82:83], v[82:83]
    v_pk_mul_f32 v[132:133], v[84:85], v[84:85]
    v_pk_mul_f32 v[134:135], v[86:87], v[86:87]
    v_pk_fma_f32 v[128:129], v[128:129], s[56:57], v[160:161]
    v_pk_fma_f32 v[130:131], v[130:131], s[56:57], v[160:161]
    v_pk_fma_f32 v[132:133], v[132:133], s[56:57], v[160:161]
    v_pk_fma_f32 v[134:135], v[134:135], s[56:57], v[160:161]
    v_pk_mul_f32 v[128:129], v[128:129], v[80:81]
    v_pk_mul_f32 v[130:131], v[130:131], v[82:83]
    v_pk_mul_f32 v[132:133], v[132:133], v[84:85]
    v_pk_mul_f32 v[134:135], v[134:135], v[86:87]
    v_exp_f32 v128, v128
    v_exp_f32 v129, v129
    v_exp_f32 v130, v130
    v_exp_f32 v131, v131
    v_exp_f32 v132, v132
    v_exp_f32 v133, v133
    v_exp_f32 v134, v134
    v_exp_f32 v135, v135
    v_pk_mul_f32 v[80:81], v[80:81], v[88:89]
    v_pk_mul_f32 v[82:83], v[82:83], v[90:91]
    v_pk_mul_f32 v[84:85], v[84:85], v[92:93]
    v_pk_mul_f32 v[86:87], v[86:87], v[94:95]
    v_pk_add_f32 v[128:129], v[128:129], 1.0 op_sel_hi:[1,0]
    v_pk_add_f32 v[130:131], v[130:131], 1.0 op_sel_hi:[1,0]
    v_pk_add_f32 v[132:133], v[132:133], 1.0 op_sel_hi:[1,0]
    v_pk_add_f32 v[134:135], v[134:135], 1.0 op_sel_hi:[1,0]
    v_rcp_f32 v128, v128
    v_rcp_f32 v129, v129
    v_rcp_f32 v130, v130
    v_rcp_f32 v131, v131
    v_rcp_f32 v132, v132
    v_rcp_f32 v133, v133
    v_rcp_f32 v134, v134
    v_rcp_f32 v135, v135
    v_pk_mul_f32 v[80:81], v[80:81], v[128:129]
    v_pk_mul_f32 v[82:83], v[82:83], v[130:131]
    v_pk_mul_f32 v[84:85], v[84:85], v[132:133]
    v_pk_mul_f32 v[86:87], v[86:87], v[134:135]
    v_cvt_pk_bf16_f32 v136, v80, v81
    v_cvt_pk_bf16_f32 v137, v82, v83
    v_cvt_pk_bf16_f32 v138, v84, v85
    v_cvt_pk_bf16_f32 v139, v86, v87
    buffer_store_dwordx4 v[136:139], v2, s[44:47], s58 offen sc1
    s_add_u32 s58, s58, 1024
    v_pk_mul_f32 v[144:145], v[96:97], v[96:97]
    v_pk_mul_f32 v[146:147], v[98:99], v[98:99]
    v_pk_mul_f32 v[148:149], v[100:101], v[100:101]
    v_pk_mul_f32 v[150:151], v[102:103], v[102:103]
    v_pk_fma_f32 v[144:145], v[144:145], s[56:57], v[160:161]
    v_pk_fma_f32 v[146:147], v[146:147], s[56:57], v[160:161]
    v_pk_fma_f32 v[148:149], v[148:149], s[56:57], v[160:161]
    v_pk_fma_f32 v[150:151], v[150:151], s[56:57], v[160:161]
    v_pk_mul_f32 v[144:145], v[144:145], v[96:97]
    v_pk_mul_f32 v[146:147], v[146:147], v[98:99]
    v_pk_mul_f32 v[148:149], v[148:149], v[100:101]
    v_pk_mul_f32 v[150:151], v[150:151], v[102:103]
    v_exp_f32 v144, v144
    v_exp_f32 v145, v145
    v_exp_f32 v146, v146
    v_exp_f32 v147, v147
    v_exp_f32 v148, v148
    v_exp_f32 v149, v149
    v_exp_f32 v150, v150
    v_exp_f32 v151, v151
    v_pk_mul_f32 v[96:97], v[96:97], v[104:105]
    v_pk_mul_f32 v[98:99], v[98:99], v[106:107]
    v_pk_mul_f32 v[100:101], v[100:101], v[108:109]
    v_pk_mul_f32 v[102:103], v[102:103], v[110:111]
    v_pk_add_f32 v[144:145], v[144:145], 1.0 op_sel_hi:[1,0]
    v_pk_add_f32 v[146:147], v[146:147], 1.0 op_sel_hi:[1,0]
    v_pk_add_f32 v[148:149], v[148:149], 1.0 op_sel_hi:[1,0]
    v_pk_add_f32 v[150:151], v[150:151], 1.0 op_sel_hi:[1,0]
    v_rcp_f32 v144, v144
    v_rcp_f32 v145, v145
    v_rcp_f32 v146, v146
    v_rcp_f32 v147, v147
    v_rcp_f32 v148, v148
    v_rcp_f32 v149, v149
    v_rcp_f32 v150, v150
    v_rcp_f32 v151, v151
    v_pk_mul_f32 v[96:97], v[96:97], v[144:145]
    v_pk_mul_f32 v[98:99], v[98:99], v[146:147]
    v_pk_mul_f32 v[100:101], v[100:101], v[148:149]
    v_pk_mul_f32 v[102:103], v[102:103], v[150:151]
    v_cvt_pk_bf16_f32 v152, v96, v97
    v_cvt_pk_bf16_f32 v153, v98, v99
    v_cvt_pk_bf16_f32 v154, v100, v101
    v_cvt_pk_bf16_f32 v155, v102, v103
    buffer_store_dwordx4 v[152:155], v2, s[44:47], s58 offen sc1
    s_add_u32 s58, s58, 1024
    v_pk_mul_f32 v[128:129], v[112:113], v[112:113]
    v_pk_mul_f32 v[130:131], v[114:115], v[114:115]
    v_pk_mul_f32 v[132:133], v[116:117], v[116:117]
    v_pk_mul_f32 v[134:135], v[118:119], v[118:119]
    v_pk_fma_f32 v[128:129], v[128:129], s[56:57], v[160:161]
    v_pk_fma_f32 v[130:131], v[130:131], s[56:57], v[160:161]
    v_pk_fma_f32 v[132:133], v[132:133], s[56:57], v[160:161]
    v_pk_fma_f32 v[134:135], v[134:135], s[56:57], v[160:161]
    v_pk_mul_f32 v[128:129], v[128:129], v[112:113]
    v_pk_mul_f32 v[130:131], v[130:131], v[114:115]
    v_pk_mul_f32 v[132:133], v[132:133], v[116:117]
    v_pk_mul_f32 v[134:135], v[134:135], v[118:119]
    v_exp_f32 v128, v128
    v_exp_f32 v129, v129
    v_exp_f32 v130, v130
    v_exp_f32 v131, v131
    v_exp_f32 v132, v132
    v_exp_f32 v133, v133
    v_exp_f32 v134, v134
    v_exp_f32 v135, v135
    v_pk_mul_f32 v[112:113], v[112:113], v[120:121]
    v_pk_mul_f32 v[114:115], v[114:115], v[122:123]
    v_pk_mul_f32 v[116:117], v[116:117], v[124:125]
    v_pk_mul_f32 v[118:119], v[118:119], v[126:127]
    v_pk_add_f32 v[128:129], v[128:129], 1.0 op_sel_hi:[1,0]
    v_pk_add_f32 v[130:131], v[130:131], 1.0 op_sel_hi:[1,0]
    v_pk_add_f32 v[132:133], v[132:133], 1.0 op_sel_hi:[1,0]
    v_pk_add_f32 v[134:135], v[134:135], 1.0 op_sel_hi:[1,0]
    v_rcp_f32 v128, v128
    v_rcp_f32 v129, v129
    v_rcp_f32 v130, v130
    v_rcp_f32 v131, v131
    v_rcp_f32 v132, v132
    v_rcp_f32 v133, v133
    v_rcp_f32 v134, v134
    v_rcp_f32 v135, v135
    v_pk_mul_f32 v[112:113], v[112:113], v[128:129]
    v_pk_mul_f32 v[114:115], v[114:115], v[130:131]
    v_pk_mul_f32 v[116:117], v[116:117], v[132:133]
    v_pk_mul_f32 v[118:119], v[118:119], v[134:135]
    v_cvt_pk_bf16_f32 v136, v112, v113
    v_cvt_pk_bf16_f32 v137, v114, v115
    v_cvt_pk_bf16_f32 v138, v116, v117
    v_cvt_pk_bf16_f32 v139, v118, v119
    buffer_store_dwordx4 v[136:139], v2, s[44:47], s58 offen sc1
    s_add_u32 s36, s28, 0x2000000
    s_addc_u32 s37, s29, 0
    s_mov_b32 s38, 0x700000
    s_mov_b32 s39, 0x20000
    s_mov_b32 s44, s24
    s_mov_b32 s45, s25
    s_mov_b32 s46, 0x200000
    s_mov_b32 s47, 0x20000
    s_mov_b32 s48, s24
    s_mov_b32 s49, s25
    s_mov_b32 s50, 0x200000
    s_mov_b32 s51, 0x20000
    s_add_u32 s40, s28, 0x1a00000
    s_addc_u32 s41, s29, 0
    s_mov_b32 s42, 0x200000
    s_mov_b32 s43, 0x20000

    s_and_b32 s34, s31, 7
    s_lshr_b32 s35, s31, 3
    s_lshl_b32 s52, s30, 2
    s_lshl_b32 s35, s35, 1
    s_add_u32 s52, s52, s35
    s_lshr_b32 s57, s33, 1
    s_and_b32 s58, s33, 1
    s_mul_i32 s53, s33, 28
    s_add_u32 s59, s52, s58
    s_mul_i32 s55, s59, 112
    s_add_u32 s55, s55, s53
    s_lshl_b32 s55, s55, 10
    s_xor_b32 s56, s58, 1
    s_add_u32 s56, s56, s52
    s_mul_i32 s56, s56, 112
    s_add_u32 s56, s56, s53
    s_lshl_b32 s56, s56, 10
    s_mul_i32 s81, s34, 7
    s_lshr_b32 s81, s81, 1
    s_mov_b32 s80, 0
    s_add_u32 s55, s55, s80
    s_add_u32 s56, s56, s80
    v_and_b32 v8, 31, v1
    v_lshrrev_b32 v9, 5, v1
    s_lshl_b32 s59, s59, 5
    v_add_u32 v8, s59, v8
    v_lshlrev_b32 v8, 10, v8
    v_lshlrev_b32 v9, 3, v9
    v_add_u32 v8, v8, v9
    s_lshl_b32 s60, s34, 7
    s_lshl_b32 s61, s57, 6
    s_add_u32 s60, s60, s61
    s_lshl_b32 s62, s30, 7
    s_lshl_b32 s61, s31, 3
    s_add_u32 s62, s62, s61
    s_lshl_b32 s61, s33, 1
    s_add_u32 s62, s62, s61
    s_lshl_b32 s62, s62, 10
    s_mul_i32 s61, s33, 12288
    s_add_u32 s61, s61, 114688
    v_add_u32 v9, s61, v2
    v_lshrrev_b32 v56, 3, v1
    v_and_b32 v57, 7, v1
    v_lshlrev_b32 v8, 10, v56
    v_lshlrev_b32 v58, 4, v57
    v_add_u32 v8, v8, v58
    s_lshl_b32 s60, s52, 5
    s_lshl_b32 s61, s33, 4
    s_add_u32 s60, s60, s61
    s_lshl_b32 s60, s60, 10
    s_lshl_b32 s61, s34, 7
    s_add_u32 s60, s60, s61
    s_add_u32 s59, s60, 8192
    v_lshrrev_b32 v58, 2, v57
    v_lshlrev_b32 v58, 1, v58
    s_lshr_b32 s61, s33, 1
    v_add_u32 v58, s61, v58
    v_mul_u32_u24 v58, 12288, v58
    s_and_b32 s61, s33, 1
    s_lshl_b32 s61, s61, 4
    v_add_u32 v56, s61, v56
    v_mul_u32_u24 v56, 144, v56
    v_add_u32 v58, v58, v56
    v_and_b32 v57, 3, v57
    v_lshlrev_b32 v57, 5, v57
    v_add_u32 v58, v58, v57
    v_add_u32 v58, 114688, v58
    v_and_b32 v56, 31, v1
    v_mul_u32_u24 v56, 144, v56
    v_lshrrev_b32 v57, 5, v1
    v_lshlrev_b32 v57, 4, v57
    v_add_u32 v56, v56, v57
    s_mul_i32 s61, s33, 12288
    s_add_u32 s61, s61, 114688
    v_add_u32 v63, s61, v56
    s_xor_b32 s61, s33, 1
    s_mul_i32 s61, s61, 12288
    s_add_u32 s61, s61, 114688
    v_add_u32 v60, s61, v2
    s_xor_b32 s61, s33, 2
    s_mul_i32 s61, s61, 12288
    s_add_u32 s61, s61, 118784
    v_add_u32 v61, s61, v2
    s_xor_b32 s61, s33, 3
    s_mul_i32 s61, s61, 12288
    s_add_u32 s61, s61, 122880
    v_add_u32 v62, s61, v2
    s_waitcnt vmcnt(0)
    s_barrier
    s_add_u32 s71, s71, 1
    s_cmp_lg_u32 s33, 0
    s_cbranch_scc1 ts_4_n
    v_mov_b32 v6, s71
    s_lshl_b32 s68, s31, 2
    s_mov_b64 exec, 1
    buffer_store_dword v6, v7, s[64:67], s68 offen
    s_mov_b64 exec, -1
ts_4_n:
    s_lshl_b32 s68, s33, 2
    s_lshl_b32 s68, 15, s68
    s_mov_b32 s69, 0
ts_4_p:

    buffer_load_dword v6, v5, s[64:67], 0 offen sc1
    s_add_u32 s69, s69, 1
    s_cmp_gt_u32 s69, 200000
    s_cbranch_scc1 ts_4_w
    s_waitcnt vmcnt(0)
    v_cmp_gt_u32 vcc, s71, v6
    s_nop 0
    s_and_b32 s63, vcc_lo, s68
    s_cmp_lg_u32 s63, 0
    s_cbranch_scc1 ts_4_p
ts_4_w:
    buffer_load_dwordx4 v[128:131], v2, s[36:39], s55 offen sc1
    s_add_u32 s55, s55, 1024
    buffer_load_dwordx4 v[132:135], v2, s[36:39], s56 offen sc1
    s_add_u32 s56, s56, 1024
    buffer_load_dwordx4 v[136:139], v2, s[36:39], s55 offen sc1
    s_add_u32 s55, s55, 1024
    buffer_load_dwordx4 v[140:143], v2, s[36:39], s56 offen sc1
    s_add_u32 s56, s56, 1024
    buffer_load_dwordx4 v[144:147], v2, s[36:39], s55 offen sc1
    s_add_u32 s55, s55, 1024
    buffer_load_dwordx4 v[148:151], v2, s[36:39], s56 offen sc1
    s_add_u32 s56, s56, 1024
    buffer_load_dwordx4 v[152:155], v2, s[36:39], s55 offen sc1
    s_add_u32 s55, s55, 1024
    buffer_load_dwordx4 v[156:159], v2, s[36:39], s56 offen sc1
    s_add_u32 s56, s56, 1024
    buffer_load_dwordx4 v[160:163], v2, s[36:39], s55 offen sc1
    s_add_u32 s55, s55, 1024
    buffer_load_dwordx4 v[164:167], v2, s[36:39], s56 offen sc1
    s_add_u32 s56, s56, 1024
    s_waitcnt vmcnt(8)
    v_mfma_f32_32x32x16_bf16 v[64:79], a[0:3], v[128:131], 0
    buffer_load_dwordx4 v[168:171], v2, s[36:39], s55 offen sc1
    s_add_u32 s55, s55, 1024
    v_mfma_f32_32x32x16_bf16 v[80:95], a[0:3], v[132:135], 0
    buffer_load_dwordx4 v[172:175], v2, s[36:39], s56 offen sc1
    s_add_u32 s56, s56, 1024
    v_mfma_f32_32x32x16_bf16 v[96:111], a[4:7], v[128:131], 0
    buffer_load_dwordx4 v[176:179], v2, s[36:39], s55 offen sc1
    s_add_u32 s55, s55, 1024
    v_mfma_f32_32x32x16_bf16 v[112:127], a[4:7], v[132:135], 0
    s_waitcnt vmcnt(9)
    v_mfma_f32_32x32x16_bf16 v[64:79], a[8:11], v[136:139], v[64:79]
    buffer_load_dwordx4 v[180:183], v2, s[36:39], s56 offen sc1
    s_add_u32 s56, s56, 1024
    v_mfma_f32_32x32x16_bf16 v[80:95], a[8:11], v[140:143], v[80:95]
    buffer_load_dwordx4 v[184:187], v2, s[36:39], s55 offen sc1
    s_add_u32 s55, s55, 1024
    v_mfma_f32_32x32x16_bf16 v[96:111], a[12:15], v[136:139], v[96:111]
    buffer_load_dwordx4 v[188:191], v2, s[36:39], s56 offen sc1
    s_add_u32 s56, s56, 1024
    v_mfma_f32_32x32x16_bf16 v[112:127], a[12:15], v[140:143], v[112:127]
    s_waitcnt vmcnt(10)
    v_mfma_f32_32x32x16_bf16 v[64:79], a[16:19], v[144:147], v[64:79]
    buffer_load_dwordx4 v[192:195], v2, s[36:39], s55 offen sc1
    s_add_u32 s55, s55, 1024
    v_mfma_f32_32x32x16_bf16 v[80:95], a[16:19], v[148:151], v[80:95]
    buffer_load_dwordx4 v[196:199], v2, s[36:39], s56 offen sc1
    s_add_u32 s56, s56, 1024
    v_mfma_f32_32x32x16_bf16 v[96:111], a[20:23], v[144:147], v[96:111]
    buffer_load_dwordx4 v[200:203], v2, s[36:39], s55 offen sc1
    s_add_u32 s55, s55, 1024
    v_mfma_f32_32x32x16_bf16 v[112:127], a[20:23], v[148:151], v[112:127]
    s_waitcnt vmcnt(11)
    v_mfma_f32_32x32x16_bf16 v[64:79], a[24:27], v[152:155], v[64:79]
    buffer_load_dwordx4 v[204:207], v2, s[36:39], s56 offen sc1
    s_add_u32 s56, s56, 1024
    v_mfma_f32_32x32x16_bf16 v[80:95], a[24:27], v[156:159], v[80:95]
    buffer_load_dwordx4 v[208:211], v2, s[36:39], s55 offen sc1
    s_add_u32 s55, s55, 1024
    v_mfma_f32_32x32x16_bf16 v[96:111], a[28:31], v[152:155], v[96:111]
    buffer_load_dwordx4 v[212:215], v2, s[36:39], s56 offen sc1
    s_add_u32 s56, s56, 1024
    v_mfma_f32_32x32x16_bf16 v[112:127], a[28:31], v[156:159], v[112:127]
    s_waitcnt vmcnt(12)
    v_mfma_f32_32x32x16_bf16 v[64:79], a[32:35], v[160:163], v[64:79]
    buffer_load_dwordx4 v[216:219], v2, s[36:39], s55 offen sc1
    s_add_u32 s55, s55, 1024
    v_mfma_f32_32x32x16_bf16 v[80:95], a[32:35], v[164:167], v[80:95]
    buffer_load_dwordx4 v[220:223], v2, s[36:39], s56 offen sc1
    s_add_u32 s56, s56, 1024
    v_mfma_f32_32x32x16_bf16 v[96:111], a[36:39], v[160:163], v[96:111]
    buffer_load_dwordx4 v[224:227], v2, s[36:39], s55 offen sc1
    s_add_u32 s55, s55, 1024
    v_mfma_f32_32x32x16_bf16 v[112:127], a[36:39], v[164:167], v[112:127]
    s_waitcnt vmcnt(13)
    v_mfma_f32_32x32x16_bf16 v[64:79], a[40:43], v[168:171], v[64:79]
    buffer_load_dwordx4 v[228:231], v2, s[36:39], s56 offen sc1
    s_add_u32 s56, s56, 1024
    v_mfma_f32_32x32x16_bf16 v[80:95], a[40:43], v[172:175], v[80:95]
    buffer_load_dwordx4 v[232:235], v2, s[36:39], s55 offen sc1
    s_add_u32 s55, s55, 1024
    v_mfma_f32_32x32x16_bf16 v[96:111], a[44:47], v[168:171], v[96:111]
    buffer_load_dwordx4 v[236:239], v2, s[36:39], s56 offen sc1
    s_add_u32 s56, s56, 1024
    v_mfma_f32_32x32x16_bf16 v[112:127], a[44:47], v[172:175], v[112:127]
    s_waitcnt vmcnt(14)
    v_mfma_f32_32x32x16_bf16 v[64:79], a[48:51], v[176:179], v[64:79]
    buffer_load_dwordx4 v[240:243], v2, s[36:39], s55 offen sc1
    s_add_u32 s55, s55, 1024
    v_mfma_f32_32x32x16_bf16 v[80:95], a[48:51], v[180:183], v[80:95]
    buffer_load_dwordx4 v[244:247], v2, s[36:39], s56 offen sc1
    s_add_u32 s56, s56, 1024
    v_mfma_f32_32x32x16_bf16 v[96:111], a[52:55], v[176:179], v[96:111]
    buffer_load_dwordx4 v[248:251], v2, s[36:39], s55 offen sc1
    s_add_u32 s55, s55, 1024
    v_mfma_f32_32x32x16_bf16 v[112:127], a[52:55], v[180:183], v[112:127]
    s_waitcnt vmcnt(15)
    v_mfma_f32_32x32x16_bf16 v[64:79], a[56:59], v[184:187], v[64:79]
    buffer_load_dwordx4 v[252:255], v2, s[36:39], s56 offen sc1
    s_add_u32 s56, s56, 1024
    v_mfma_f32_32x32x16_bf16 v[80:95], a[56:59], v[188:191], v[80:95]
    buffer_load_dwordx4 v[128:131], v2, s[36:39], s55 offen sc1
    s_add_u32 s55, s55, 1024
    v_mfma_f32_32x32x16_bf16 v[96:111], a[60:63], v[184:187], v[96:111]
    buffer_load_dwordx4 v[132:135], v2, s[36:39], s56 offen sc1
    s_add_u32 s56, s56, 1024
    v_mfma_f32_32x32x16_bf16 v[112:127], a[60:63], v[188:191], v[112:127]
    s_waitcnt vmcnt(16)
    v_mfma_f32_32x32x16_bf16 v[64:79], a[64:67], v[192:195], v[64:79]
    buffer_load_dwordx4 v[136:139], v2, s[36:39], s55 offen sc1
    s_add_u32 s55, s55, 1024
    v_mfma_f32_32x32x16_bf16 v[80:95], a[64:67], v[196:199], v[80:95]
    buffer_load_dwordx4 v[140:143], v2, s[36:39], s56 offen sc1
    s_add_u32 s56, s56, 1024
    v_mfma_f32_32x32x16_bf16 v[96:111], a[68:71], v[192:195], v[96:111]
    buffer_load_dwordx4 v[144:147], v2, s[36:39], s55 offen sc1
    s_add_u32 s55, s55, 1024
    v_mfma_f32_32x32x16_bf16 v[112:127], a[68:71], v[196:199], v[112:127]
    s_waitcnt vmcnt(17)
    v_mfma_f32_32x32x16_bf16 v[64:79], a[72:75], v[200:203], v[64:79]
    buffer_load_dwordx4 v[148:151], v2, s[36:39], s56 offen sc1
    s_add_u32 s56, s56, 1024
    v_mfma_f32_32x32x16_bf16 v[80:95], a[72:75], v[204:207], v[80:95]
    buffer_load_dwordx4 v[152:155], v2, s[36:39], s55 offen sc1
    s_add_u32 s55, s55, 1024
    v_mfma_f32_32x32x16_bf16 v[96:111], a[76:79], v[200:203], v[96:111]
    buffer_load_dwordx4 v[156:159], v2, s[36:39], s56 offen sc1
    s_add_u32 s56, s56, 1024
    v_mfma_f32_32x32x16_bf16 v[112:127], a[76:79], v[204:207], v[112:127]
    s_waitcnt vmcnt(18)
    v_mfma_f32_32x32x16_bf16 v[64:79], a[80:83], v[208:211], v[64:79]
    buffer_load_dwordx4 v[160:163], v2, s[36:39], s55 offen sc1
    s_add_u32 s55, s55, 1024
    v_mfma_f32_32x32x16_bf16 v[80:95], a[80:83], v[212:215], v[80:95]
    buffer_load_dwordx4 v[164:167], v2, s[36:39], s56 offen sc1
    s_add_u32 s56, s56, 1024
    v_mfma_f32_32x32x16_bf16 v[96:111], a[84:87], v[208:211], v[96:111]
    buffer_load_dwordx4 v[168:171], v2, s[36:39], s55 offen sc1
    s_add_u32 s55, s55, 1024
    v_mfma_f32_32x32x16_bf16 v[112:127], a[84:87], v[212:215], v[112:127]
    s_waitcnt vmcnt(19)
    v_mfma_f32_32x32x16_bf16 v[64:79], a[88:91], v[216:219], v[64:79]
    buffer_load_dwordx4 v[172:175], v2, s[36:39], s56 offen sc1
    s_add_u32 s56, s56, 1024
    v_mfma_f32_32x32x16_bf16 v[80:95], a[88:91], v[220:223], v[80:95]
    buffer_load_dwordx4 v[176:179], v2, s[36:39], s55 offen sc1
    s_add_u32 s55, s55, 1024
    v_mfma_f32_32x32x16_bf16 v[96:111], a[92:95], v[216:219], v[96:111]
    buffer_load_dwordx4 v[180:183], v2, s[36:39], s56 offen sc1
    s_add_u32 s56, s56, 1024
    v_mfma_f32_32x32x16_bf16 v[112:127], a[92:95], v[220:223], v[112:127]
    s_waitcnt vmcnt(20)
    v_mfma_f32_32x32x16_bf16 v[64:79], a[96:99], v[224:227], v[64:79]
    buffer_load_dwordx4 v[184:187], v2, s[36:39], s55 offen sc1
    s_add_u32 s55, s55, 1024
    v_mfma_f32_32x32x16_bf16 v[80:95], a[96:99], v[228:231], v[80:95]
    buffer_load_dwordx4 v[188:191], v2, s[36:39], s56 offen sc1
    s_add_u32 s56, s56, 1024
    v_mfma_f32_32x32x16_bf16 v[96:111], a[100:103], v[224:227], v[96:111]
    v_mfma_f32_32x32x16_bf16 v[112:127], a[100:103], v[228:231], v[112:127]
    s_waitcnt vmcnt(20)
    v_mfma_f32_32x32x16_bf16 v[64:79], a[104:107], v[232:235], v[64:79]
    buffer_load_dwordx4 v[192:195], v2, s[36:39], s55 offen sc1
    s_add_u32 s55, s55, 1024
    v_mfma_f32_32x32x16_bf16 v[80:95], a[104:107], v[236:239], v[80:95]
    buffer_load_dwordx4 v[196:199], v2, s[36:39], s56 offen sc1
    s_add_u32 s56, s56, 1024
    v_mfma_f32_32x32x16_bf16 v[96:111], a[108:111], v[232:235], v[96:111]
    v_mfma_f32_32x32x16_bf16 v[112:127], a[108:111], v[236:239], v[112:127]
    s_waitcnt vmcnt(20)
    v_mfma_f32_32x32x16_bf16 v[64:79], a[112:115], v[240:243], v[64:79]
    buffer_load_dwordx4 v[200:203], v2, s[36:39], s55 offen sc1
    s_add_u32 s55, s55, 1024
    v_mfma_f32_32x32x16_bf16 v[80:95], a[112:115], v[244:247], v[80:95]
    buffer_load_dwordx4 v[204:207], v2, s[36:39], s56 offen sc1
    s_add_u32 s56, s56, 1024
    v_mfma_f32_32x32x16_bf16 v[96:111], a[116:119], v[240:243], v[96:111]
    v_mfma_f32_32x32x16_bf16 v[112:127], a[116:119], v[244:247], v[112:127]
    s_waitcnt vmcnt(20)
    v_mfma_f32_32x32x16_bf16 v[64:79], a[120:123], v[248:251], v[64:79]
    buffer_load_dwordx4 v[208:211], v2, s[36:39], s55 offen sc1
    s_add_u32 s55, s55, 1024
    v_mfma_f32_32x32x16_bf16 v[80:95], a[120:123], v[252:255], v[80:95]
    buffer_load_dwordx4 v[212:215], v2, s[36:39], s56 offen sc1
    s_add_u32 s56, s56, 1024
    v_mfma_f32_32x32x16_bf16 v[96:111], a[124:127], v[248:251], v[96:111]
    v_mfma_f32_32x32x16_bf16 v[112:127], a[124:127], v[252:255], v[112:127]
    s_waitcnt vmcnt(20)
    v_mfma_f32_32x32x16_bf16 v[64:79], a[128:131], v[128:131], v[64:79]
    buffer_load_dwordx4 v[216:219], v2, s[36:39], s55 offen sc1
    s_add_u32 s55, s55, 1024
    v_mfma_f32_32x32x16_bf16 v[80:95], a[128:131], v[132:135], v[80:95]
    buffer_load_dwordx4 v[220:223], v2, s[36:39], s56 offen sc1
    s_add_u32 s56, s56, 1024
    v_mfma_f32_32x32x16_bf16 v[96:111], a[132:135], v[128:131], v[96:111]
    v_mfma_f32_32x32x16_bf16 v[112:127], a[132:135], v[132:135], v[112:127]
    buffer_load_dwordx4 v[16:19], v8, s[44:47], s60 offen sc1
    buffer_load_dwordx4 v[20:23], v8, s[44:47], s59 offen sc1
    buffer_load_dwordx4 v[24:27], v2, s[40:43], s62 offen sc1
    buffer_load_dwordx4 v[28:31], v2, s[40:43], s62 offen offset:1024 sc1
    s_waitcnt vmcnt(24)
    v_mfma_f32_32x32x16_bf16 v[64:79], a[136:139], v[136:139], v[64:79]
    v_mfma_f32_32x32x16_bf16 v[80:95], a[136:139], v[140:143], v[80:95]
    v_mfma_f32_32x32x16_bf16 v[96:111], a[140:143], v[136:139], v[96:111]
    v_mfma_f32_32x32x16_bf16 v[112:127], a[140:143], v[140:143], v[112:127]
    s_waitcnt vmcnt(22)
    v_mfma_f32_32x32x16_bf16 v[64:79], a[144:147], v[144:147], v[64:79]
    v_mfma_f32_32x32x16_bf16 v[80:95], a[144:147], v[148:151], v[80:95]
    v_mfma_f32_32x32x16_bf16 v[96:111], a[148:151], v[144:147], v[96:111]
    v_mfma_f32_32x32x16_bf16 v[112:127], a[148:151], v[148:151], v[112:127]
    s_waitcnt vmcnt(20)
    v_mfma_f32_32x32x16_bf16 v[64:79], a[152:155], v[152:155], v[64:79]
    v_mfma_f32_32x32x16_bf16 v[80:95], a[152:155], v[156:159], v[80:95]
    v_mfma_f32_32x32x16_bf16 v[96:111], a[156:159], v[152:155], v[96:111]
    v_mfma_f32_32x32x16_bf16 v[112:127], a[156:159], v[156:159], v[112:127]
    s_waitcnt vmcnt(18)
    v_mfma_f32_32x32x16_bf16 v[64:79], a[160:163], v[160:163], v[64:79]
    v_mfma_f32_32x32x16_bf16 v[80:95], a[160:163], v[164:167], v[80:95]
    v_mfma_f32_32x32x16_bf16 v[96:111], a[164:167], v[160:163], v[96:111]
    v_mfma_f32_32x32x16_bf16 v[112:127], a[164:167], v[164:167], v[112:127]
    s_waitcnt vmcnt(16)
    v_mfma_f32_32x32x16_bf16 v[64:79], a[168:171], v[168:171], v[64:79]
    v_mfma_f32_32x32x16_bf16 v[80:95], a[168:171], v[172:175], v[80:95]
    v_mfma_f32_32x32x16_bf16 v[96:111], a[172:175], v[168:171], v[96:111]
    v_mfma_f32_32x32x16_bf16 v[112:127], a[172:175], v[172:175], v[112:127]
    s_waitcnt vmcnt(14)
    v_mfma_f32_32x32x16_bf16 v[64:79], a[176:179], v[176:179], v[64:79]
    v_mfma_f32_32x32x16_bf16 v[80:95], a[176:179], v[180:183], v[80:95]
    v_mfma_f32_32x32x16_bf16 v[96:111], a[180:183], v[176:179], v[96:111]
    v_mfma_f32_32x32x16_bf16 v[112:127], a[180:183], v[180:183], v[112:127]
    s_waitcnt vmcnt(12)
    v_mfma_f32_32x32x16_bf16 v[64:79], a[184:187], v[184:187], v[64:79]
    v_mfma_f32_32x32x16_bf16 v[80:95], a[184:187], v[188:191], v[80:95]
    v_mfma_f32_32x32x16_bf16 v[96:111], a[188:191], v[184:187], v[96:111]
    v_mfma_f32_32x32x16_bf16 v[112:127], a[188:191], v[188:191], v[112:127]
    s_waitcnt vmcnt(10)
    v_mfma_f32_32x32x16_bf16 v[64:79], a[192:195], v[192:195], v[64:79]
    v_mfma_f32_32x32x16_bf16 v[80:95], a[192:195], v[196:199], v[80:95]
    v_mfma_f32_32x32x16_bf16 v[96:111], a[196:199], v[192:195], v[96:111]
    v_mfma_f32_32x32x16_bf16 v[112:127], a[196:199], v[196:199], v[112:127]
    s_waitcnt vmcnt(8)
    v_mfma_f32_32x32x16_bf16 v[64:79], a[200:203], v[200:203], v[64:79]
    v_mfma_f32_32x32x16_bf16 v[80:95], a[200:203], v[204:207], v[80:95]
    v_mfma_f32_32x32x16_bf16 v[96:111], a[204:207], v[200:203], v[96:111]
    v_mfma_f32_32x32x16_bf16 v[112:127], a[204:207], v[204:207], v[112:127]
    s_waitcnt vmcnt(6)
    v_mfma_f32_32x32x16_bf16 v[64:79], a[208:211], v[208:211], v[64:79]
    v_mfma_f32_32x32x16_bf16 v[80:95], a[208:211], v[212:215], v[80:95]
    v_mfma_f32_32x32x16_bf16 v[96:111], a[212:215], v[208:211], v[96:111]
    v_mfma_f32_32x32x16_bf16 v[112:127], a[212:215], v[212:215], v[112:127]
    s_waitcnt vmcnt(4)
    v_mfma_f32_32x32x16_bf16 v[80:95], a[216:219], v[220:223], v[80:95]
    v_mfma_f32_32x32x16_bf16 v[96:111], a[220:223], v[216:219], v[96:111]
    v_mfma_f32_32x32x16_bf16 v[112:127], a[220:223], v[220:223], v[112:127]
    v_mfma_f32_32x32x16_bf16 v[64:79], a[216:219], v[216:219], v[64:79]
    s_nop 8
    ds_write_b128 v60, v[80:83] offset:0
    ds_write_b128 v60, v[84:87] offset:1024
    ds_write_b128 v60, v[88:91] offset:2048
    ds_write_b128 v60, v[92:95] offset:3072
    ds_write_b128 v61, v[96:99] offset:0
    ds_write_b128 v61, v[100:103] offset:1024
    ds_write_b128 v61, v[104:107] offset:2048
    ds_write_b128 v61, v[108:111] offset:3072
    ds_write_b128 v62, v[112:115] offset:0
    ds_write_b128 v62, v[116:119] offset:1024
    ds_write_b128 v62, v[120:123] offset:2048
    ds_write_b128 v62, v[124:127] offset:3072
    s_waitcnt lgkmcnt(0)
    s_barrier
    ds_read_b128 v[128:131], v9 offset:0
    ds_read_b128 v[132:135], v9 offset:1024
    ds_read_b128 v[136:139], v9 offset:2048
    ds_read_b128 v[140:143], v9 offset:3072
    ds_read_b128 v[144:147], v9 offset:4096
    ds_read_b128 v[148:151], v9 offset:5120
    ds_read_b128 v[152:155], v9 offset:6144
    ds_read_b128 v[156:159], v9 offset:7168
    ds_read_b128 v[160:163], v9 offset:8192
    ds_read_b128 v[164:167], v9 offset:9216
    ds_read_b128 v[168:171], v9 offset:10240
    ds_read_b128 v[172:175], v9 offset:11264
    s_waitcnt lgkmcnt(8)
    v_pk_add_f32 v[64:65], v[64:65], v[128:129]
    v_pk_add_f32 v[66:67], v[66:67], v[130:131]
    v_pk_add_f32 v[68:69], v[68:69], v[132:133]
    v_pk_add_f32 v[70:71], v[70:71], v[134:135]
    v_pk_add_f32 v[72:73], v[72:73], v[136:137]
    v_pk_add_f32 v[74:75], v[74:75], v[138:139]
    v_pk_add_f32 v[76:77], v[76:77], v[140:141]
    v_pk_add_f32 v[78:79], v[78:79], v[142:143]
    s_waitcnt lgkmcnt(4)
    v_pk_add_f32 v[64:65], v[64:65], v[144:145]
    v_pk_add_f32 v[66:67], v[66:67], v[146:147]
    v_pk_add_f32 v[68:69], v[68:69], v[148:149]
    v_pk_add_f32 v[70:71], v[70:71], v[150:151]
    v_pk_add_f32 v[72:73], v[72:73], v[152:153]
    v_pk_add_f32 v[74:75], v[74:75], v[154:155]
    v_pk_add_f32 v[76:77], v[76:77], v[156:157]
    v_pk_add_f32 v[78:79], v[78:79], v[158:159]
    s_waitcnt lgkmcnt(0)
    v_pk_add_f32 v[64:65], v[64:65], v[160:161]
    v_pk_add_f32 v[66:67], v[66:67], v[162:163]
    v_pk_add_f32 v[68:69], v[68:69], v[164:165]
    v_pk_add_f32 v[70:71], v[70:71], v[166:167]
    v_pk_add_f32 v[72:73], v[72:73], v[168:169]
    v_pk_add_f32 v[74:75], v[74:75], v[170:171]
    v_pk_add_f32 v[76:77], v[76:77], v[172:173]
    v_pk_add_f32 v[78:79], v[78:79], v[174:175]
    ds_write_b128 v63, v[64:67] offset:0
    ds_write_b128 v63, v[68:71] offset:32
    ds_write_b128 v63, v[72:75] offset:64
    ds_write_b128 v63, v[76:79] offset:96
    s_waitcnt lgkmcnt(0)
    s_barrier
    ds_read_b128 v[128:131], v58 offset:0
    ds_read_b128 v[132:135], v58 offset:16
    ds_read_b128 v[136:139], v58 offset:1152
    ds_read_b128 v[140:143], v58 offset:1168
    s_waitcnt vmcnt(0)
    v_lshlrev_b32 v32, 16, v16
    v_and_b32 v33, 0xffff0000, v16
    v_lshlrev_b32 v34, 16, v17
    v_and_b32 v35, 0xffff0000, v17
    v_lshlrev_b32 v36, 16, v18
    v_and_b32 v37, 0xffff0000, v18
    v_lshlrev_b32 v38, 16, v19
    v_and_b32 v39, 0xffff0000, v19
    v_lshlrev_b32 v40, 16, v20
    v_and_b32 v41, 0xffff0000, v20
    v_lshlrev_b32 v42, 16, v21
    v_and_b32 v43, 0xffff0000, v21
    v_lshlrev_b32 v44, 16, v22
    v_and_b32 v45, 0xffff0000, v22
    v_lshlrev_b32 v46, 16, v23
    v_and_b32 v47, 0xffff0000, v23
    s_waitcnt lgkmcnt(0)
    v_pk_add_f32 v[32:33], v[32:33], v[128:129]
    v_pk_add_f32 v[34:35], v[34:35], v[130:131]
    v_pk_add_f32 v[36:37], v[36:37], v[132:133]
    v_pk_add_f32 v[38:39], v[38:39], v[134:135]
    v_pk_add_f32 v[40:41], v[40:41], v[136:137]
    v_pk_add_f32 v[42:43], v[42:43], v[138:139]
    v_pk_add_f32 v[44:45], v[44:45], v[140:141]
    v_pk_add_f32 v[46:47], v[46:47], v[142:143]
    v_cvt_pk_bf16_f32 v48, v32, v33
    v_cvt_pk_bf16_f32 v49, v34, v35
    v_cvt_pk_bf16_f32 v50, v36, v37
    v_cvt_pk_bf16_f32 v51, v38, v39
    v_cvt_pk_bf16_f32 v52, v40, v41
    v_cvt_pk_bf16_f32 v53, v42, v43
    v_cvt_pk_bf16_f32 v54, v44, v45
    v_cvt_pk_bf16_f32 v55, v46, v47
    buffer_store_dwordx4 v[48:51], v8, s[48:51], s60 offen
    buffer_store_dwordx4 v[52:55], v8, s[48:51], s59 offen
    s_cmp_lg_u32 s70, 0
    s_cbranch_scc1 chain_done2
    s_mov_b32 s36, s24
    s_mov_b32 s37, s25
    s_mov_b32 s38, 0x200000
    s_mov_b32 s39, 0x20000
    s_mov_b32 s44, s24
    s_mov_b32 s45, s25
    s_mov_b32 s46, 0x200000
    s_mov_b32 s47, 0x20000
    s_add_u32 s48, s28, 0x1000000
    s_addc_u32 s49, s29, 0
    s_mov_b32 s50, 0x200000
    s_mov_b32 s51, 0x20000
    s_waitcnt vmcnt(0)
    s_barrier
    s_add_u32 s71, s71, 1
    s_cmp_lg_u32 s33, 0
    s_cbranch_scc1 ts_5_n
    v_mov_b32 v6, s71
    s_lshl_b32 s68, s31, 2
    s_mov_b64 exec, 1
    buffer_store_dword v6, v7, s[64:67], s68 offen
    s_mov_b64 exec, -1
ts_5_n:
    s_and_b32 s68, s31, 8
    s_lshl_b32 s68, 0xff, s68
    s_mov_b32 s69, 0
ts_5_p:

    buffer_load_dword v6, v5, s[64:67], 0 offen sc1
    s_add_u32 s69, s69, 1
    s_cmp_gt_u32 s69, 200000
    s_cbranch_scc1 ts_5_w
    s_waitcnt vmcnt(0)
    v_cmp_gt_u32 vcc, s71, v6
    s_nop 0
    s_and_b32 s63, vcc_lo, s68
    s_cmp_lg_u32 s63, 0
    s_cbranch_scc1 ts_5_p
ts_5_w:

    s_lshl_b32 s34, s30, 7
    s_lshl_b32 s35, s31, 3
    s_add_u32 s32, s34, s35
    s_lshl_b32 s34, s33, 1
    s_add_u32 s34, s34, s32
    s_lshl_b32 s35, s34, 10
    buffer_load_dwordx4 v[80:83], v2, s[36:39], s35 offen sc1
    buffer_load_dwordx4 v[84:87], v2, s[36:39], s35 offen offset:1024 sc1
    s_waitcnt vmcnt(0)
    v_lshlrev_b32 v32, 16, v80
    v_and_b32 v33, 0xffff0000, v80
    v_lshlrev_b32 v34, 16, v81
    v_and_b32 v35, 0xffff0000, v81
    v_lshlrev_b32 v36, 16, v82
    v_and_b32 v37, 0xffff0000, v82
    v_lshlrev_b32 v38, 16, v83
    v_and_b32 v39, 0xffff0000, v83
    v_lshlrev_b32 v40, 16, v84
    v_and_b32 v41, 0xffff0000, v84
    v_lshlrev_b32 v42, 16, v85
    v_and_b32 v43, 0xffff0000, v85
    v_lshlrev_b32 v44, 16, v86
    v_and_b32 v45, 0xffff0000, v86
    v_lshlrev_b32 v46, 16, v87
    v_and_b32 v47, 0xffff0000, v87
    v_readfirstlane_b32 s56, v32
    v_readfirstlane_b32 s58, v40
    s_nop 0
    v_pk_add_f32 v[48:49], v[32:33], s[56:57] op_sel_hi:[1,0] neg_lo:[0,1] neg_hi:[0,1]
    v_pk_add_f32 v[50:51], v[34:35], s[56:57] op_sel_hi:[1,0] neg_lo:[0,1] neg_hi:[0,1]
    v_pk_add_f32 v[52:53], v[36:37], s[56:57] op_sel_hi:[1,0] neg_lo:[0,1] neg_hi:[0,1]
    v_pk_add_f32 v[54:55], v[38:39], s[56:57] op_sel_hi:[1,0] neg_lo:[0,1] neg_hi:[0,1]
    v_pk_add_f32 v[56:57], v[40:41], s[58:59] op_sel_hi:[1,0] neg_lo:[0,1] neg_hi:[0,1]
    v_pk_add_f32 v[58:59], v[42:43], s[58:59] op_sel_hi:[1,0] neg_lo:[0,1] neg_hi:[0,1]
    v_pk_add_f32 v[60:61], v[44:45], s[58:59] op_sel_hi:[1,0] neg_lo:[0,1] neg_hi:[0,1]
    v_pk_add_f32 v[62:63], v[46:47], s[58:59] op_sel_hi:[1,0] neg_lo:[0,1] neg_hi:[0,1]
    v_pk_add_f32 v[16:17], v[48:49], v[50:51]
    v_pk_mul_f32 v[18:19], v[48:49], v[48:49]
    v_pk_add_f32 v[20:21], v[56:57], v[58:59]
    v_pk_mul_f32 v[22:23], v[56:57], v[56:57]
    v_pk_add_f32 v[16:17], v[16:17], v[52:53]
    v_pk_fma_f32 v[18:19], v[50:51], v[50:51], v[18:19]
    v_pk_add_f32 v[20:21], v[20:21], v[60:61]
    v_pk_fma_f32 v[22:23], v[58:59], v[58:59], v[22:23]
    v_pk_add_f32 v[16:17], v[16:17], v[54:55]
    v_pk_fma_f32 v[18:19], v[52:53], v[52:53], v[18:19]
    v_pk_add_f32 v[20:21], v[20:21], v[62:63]
    v_pk_fma_f32 v[22:23], v[60:61], v[60:61], v[22:23]
    v_pk_fma_f32 v[18:19], v[54:55], v[54:55], v[18:19]
    v_add_f32 v16, v16, v17
    v_pk_fma_f32 v[22:23], v[62:63], v[62:63], v[22:23]
    v_add_f32 v20, v20, v21
    v_add_f32 v18, v18, v19
    v_add_f32 v22, v22, v23
    v_add_f32_dpp v16, v16, v16 row_shr:1 row_mask:0xf bank_mask:0xf
    v_add_f32_dpp v18, v18, v18 row_shr:1 row_mask:0xf bank_mask:0xf
    v_add_f32_dpp v20, v20, v20 row_shr:1 row_mask:0xf bank_mask:0xf
    v_add_f32_dpp v22, v22, v22 row_shr:1 row_mask:0xf bank_mask:0xf
    v_add_f32_dpp v16, v16, v16 row_shr:2 row_mask:0xf bank_mask:0xf
    v_add_f32_dpp v18, v18, v18 row_shr:2 row_mask:0xf bank_mask:0xf
    v_add_f32_dpp v20, v20, v20 row_shr:2 row_mask:0xf bank_mask:0xf
    v_add_f32_dpp v22, v22, v22 row_shr:2 row_mask:0xf bank_mask:0xf
    v_add_f32_dpp v16, v16, v16 row_shr:4 row_mask:0xf bank_mask:0xf
    v_add_f32_dpp v18, v18, v18 row_shr:4 row_mask:0xf bank_mask:0xf
    v_add_f32_dpp v20, v20, v20 row_shr:4 row_mask:0xf bank_mask:0xf
    v_add_f32_dpp v22, v22, v22 row_shr:4 row_mask:0xf bank_mask:0xf
    v_add_f32_dpp v16, v16, v16 row_shr:8 row_mask:0xf bank_mask:0xf
    v_add_f32_dpp v18, v18, v18 row_shr:8 row_mask:0xf bank_mask:0xf
    v_add_f32_dpp v20, v20, v20 row_shr:8 row_mask:0xf bank_mask:0xf
    v_add_f32_dpp v22, v22, v22 row_shr:8 row_mask:0xf bank_mask:0xf
    v_add_f32_dpp v16, v16, v16 row_bcast:15 row_mask:0xa bank_mask:0xf
    v_add_f32_dpp v18, v18, v18 row_bcast:15 row_mask:0xa bank_mask:0xf
    v_add_f32_dpp v20, v20, v20 row_bcast:15 row_mask:0xa bank_mask:0xf
    v_add_f32_dpp v22, v22, v22 row_bcast:15 row_mask:0xa bank_mask:0xf
    v_add_f32_dpp v16, v16, v16 row_bcast:31 row_mask:0xc bank_mask:0xf
    v_add_f32_dpp v18, v18, v18 row_bcast:31 row_mask:0xc bank_mask:0xf
    v_add_f32_dpp v20, v20, v20 row_bcast:31 row_mask:0xc bank_mask:0xf
    v_add_f32_dpp v22, v22, v22 row_bcast:31 row_mask:0xc bank_mask:0xf
    v_readlane_b32 s60, v16, 63
    v_readlane_b32 s61, v18, 63
    v_readlane_b32 s62, v20, 63
    v_readlane_b32 s63, v22, 63
    v_mov_b32 v16, s60
    v_mov_b32 v18, s61
    v_mov_b32 v20, s62
    v_mov_b32 v22, s63
    v_mul_f32 v16, 0x3b000000, v16
    v_mul_f32 v18, 0x3b000000, v18
    v_mul_f32 v20, 0x3b000000, v20
    v_mul_f32 v22, 0x3b000000, v22
    v_fma_f32 v18, -v16, v16, v18
    v_fma_f32 v22, -v20, v20, v22
    v_max_f32 v18, 0, v18
    v_max_f32 v22, 0, v22
    v_add_f32 v18, 0x3727c5ac, v18
    v_add_f32 v22, 0x3727c5ac, v22
    v_rsq_f32 v18, v18
    v_rsq_f32 v22, v22
    v_mul_f32 v16, v16, v18
    v_mul_f32 v20, v20, v22
    v_pk_fma_f32 v[48:49], v[48:49], v[18:19], v[16:17] op_sel_hi:[1,0,0] neg_lo:[0,0,1] neg_hi:[0,0,1]
    v_pk_fma_f32 v[50:51], v[50:51], v[18:19], v[16:17] op_sel_hi:[1,0,0] neg_lo:[0,0,1] neg_hi:[0,0,1]
    v_pk_fma_f32 v[52:53], v[52:53], v[18:19], v[16:17] op_sel_hi:[1,0,0] neg_lo:[0,0,1] neg_hi:[0,0,1]
    v_pk_fma_f32 v[54:55], v[54:55], v[18:19], v[16:17] op_sel_hi:[1,0,0] neg_lo:[0,0,1] neg_hi:[0,0,1]
    v_pk_fma_f32 v[56:57], v[56:57], v[22:23], v[20:21] op_sel_hi:[1,0,0] neg_lo:[0,0,1] neg_hi:[0,0,1]
    v_pk_fma_f32 v[58:59], v[58:59], v[22:23], v[20:21] op_sel_hi:[1,0,0] neg_lo:[0,0,1] neg_hi:[0,0,1]
    v_pk_fma_f32 v[60:61], v[60:61], v[22:23], v[20:21] op_sel_hi:[1,0,0] neg_lo:[0,0,1] neg_hi:[0,0,1]
    v_pk_fma_f32 v[62:63], v[62:63], v[22:23], v[20:21] op_sel_hi:[1,0,0] neg_lo:[0,0,1] neg_hi:[0,0,1]
    v_lshlrev_b32 v64, 16, v24
    v_and_b32 v65, 0xffff0000, v24
    v_lshlrev_b32 v66, 16, v25
    v_and_b32 v67, 0xffff0000, v25
    v_lshlrev_b32 v68, 16, v26
    v_and_b32 v69, 0xffff0000, v26
    v_lshlrev_b32 v70, 16, v27
    v_and_b32 v71, 0xffff0000, v27
    v_lshlrev_b32 v72, 16, v28
    v_and_b32 v73, 0xffff0000, v28
    v_lshlrev_b32 v74, 16, v29
    v_and_b32 v75, 0xffff0000, v29
    v_lshlrev_b32 v76, 16, v30
    v_and_b32 v77, 0xffff0000, v30
    v_lshlrev_b32 v78, 16, v31
    v_and_b32 v79, 0xffff0000, v31
    v_pk_fma_f32 v[32:33], v[48:49], v[64:65], v[32:33]
    v_pk_fma_f32 v[40:41], v[56:57], v[72:73], v[40:41]
    v_pk_fma_f32 v[34:35], v[50:51], v[66:67], v[34:35]
    v_pk_fma_f32 v[42:43], v[58:59], v[74:75], v[42:43]
    v_pk_fma_f32 v[36:37], v[52:53], v[68:69], v[36:37]
    v_pk_fma_f32 v[44:45], v[60:61], v[76:77], v[44:45]
    v_pk_fma_f32 v[38:39], v[54:55], v[70:71], v[38:39]
    v_pk_fma_f32 v[46:47], v[62:63], v[78:79], v[46:47]
    v_cvt_pk_bf16_f32 v80, v32, v33
    v_cvt_pk_bf16_f32 v84, v40, v41
    v_cvt_pk_bf16_f32 v81, v34, v35
    v_cvt_pk_bf16_f32 v85, v42, v43
    v_cvt_pk_bf16_f32 v82, v36, v37
    v_cvt_pk_bf16_f32 v86, v44, v45
    v_cvt_pk_bf16_f32 v83, v38, v39
    v_cvt_pk_bf16_f32 v87, v46, v47
    buffer_store_dwordx4 v[80:83], v2, s[44:47], s35 offen
    buffer_store_dwordx4 v[84:87], v2, s[44:47], s35 offen offset:1024
    v_lshlrev_b32 v32, 16, v80
    v_and_b32 v33, 0xffff0000, v80
    v_lshlrev_b32 v34, 16, v81
    v_and_b32 v35, 0xffff0000, v81
    v_lshlrev_b32 v36, 16, v82
    v_and_b32 v37, 0xffff0000, v82
    v_lshlrev_b32 v38, 16, v83
    v_and_b32 v39, 0xffff0000, v83
    v_lshlrev_b32 v40, 16, v84
    v_and_b32 v41, 0xffff0000, v84
    v_lshlrev_b32 v42, 16, v85
    v_and_b32 v43, 0xffff0000, v85
    v_lshlrev_b32 v44, 16, v86
    v_and_b32 v45, 0xffff0000, v86
    v_lshlrev_b32 v46, 16, v87
    v_and_b32 v47, 0xffff0000, v87
    v_readfirstlane_b32 s56, v32
    v_readfirstlane_b32 s58, v40
    s_nop 0
    v_pk_add_f32 v[48:49], v[32:33], s[56:57] op_sel_hi:[1,0] neg_lo:[0,1] neg_hi:[0,1]
    v_pk_add_f32 v[50:51], v[34:35], s[56:57] op_sel_hi:[1,0] neg_lo:[0,1] neg_hi:[0,1]
    v_pk_add_f32 v[52:53], v[36:37], s[56:57] op_sel_hi:[1,0] neg_lo:[0,1] neg_hi:[0,1]
    v_pk_add_f32 v[54:55], v[38:39], s[56:57] op_sel_hi:[1,0] neg_lo:[0,1] neg_hi:[0,1]
    v_pk_add_f32 v[56:57], v[40:41], s[58:59] op_sel_hi:[1,0] neg_lo:[0,1] neg_hi:[0,1]
    v_pk_add_f32 v[58:59], v[42:43], s[58:59] op_sel_hi:[1,0] neg_lo:[0,1] neg_hi:[0,1]
    v_pk_add_f32 v[60:61], v[44:45], s[58:59] op_sel_hi:[1,0] neg_lo:[0,1] neg_hi:[0,1]
    v_pk_add_f32 v[62:63], v[46:47], s[58:59] op_sel_hi:[1,0] neg_lo:[0,1] neg_hi:[0,1]
    v_pk_add_f32 v[16:17], v[48:49], v[50:51]
    v_pk_mul_f32 v[18:19], v[48:49], v[48:49]
    v_pk_add_f32 v[20:21], v[56:57], v[58:59]
    v_pk_mul_f32 v[22:23], v[56:57], v[56:57]
    v_pk_add_f32 v[16:17], v[16:17], v[52:53]
    v_pk_fma_f32 v[18:19], v[50:51], v[50:51], v[18:19]
    v_pk_add_f32 v[20:21], v[20:21], v[60:61]
    v_pk_fma_f32 v[22:23], v[58:59], v[58:59], v[22:23]
    v_pk_add_f32 v[16:17], v[16:17], v[54:55]
    v_pk_fma_f32 v[18:19], v[52:53], v[52:53], v[18:19]
    v_pk_add_f32 v[20:21], v[20:21], v[62:63]
    v_pk_fma_f32 v[22:23], v[60:61], v[60:61], v[22:23]
    v_pk_fma_f32 v[18:19], v[54:55], v[54:55], v[18:19]
    v_add_f32 v16, v16, v17
    v_pk_fma_f32 v[22:23], v[62:63], v[62:63], v[22:23]
    v_add_f32 v20, v20, v21
    v_add_f32 v18, v18, v19
    v_add_f32 v22, v22, v23
    v_add_f32_dpp v16, v16, v16 row_shr:1 row_mask:0xf bank_mask:0xf
    v_add_f32_dpp v18, v18, v18 row_shr:1 row_mask:0xf bank_mask:0xf
    v_add_f32_dpp v20, v20, v20 row_shr:1 row_mask:0xf bank_mask:0xf
    v_add_f32_dpp v22, v22, v22 row_shr:1 row_mask:0xf bank_mask:0xf
    v_add_f32_dpp v16, v16, v16 row_shr:2 row_mask:0xf bank_mask:0xf
    v_add_f32_dpp v18, v18, v18 row_shr:2 row_mask:0xf bank_mask:0xf
    v_add_f32_dpp v20, v20, v20 row_shr:2 row_mask:0xf bank_mask:0xf
    v_add_f32_dpp v22, v22, v22 row_shr:2 row_mask:0xf bank_mask:0xf
    v_add_f32_dpp v16, v16, v16 row_shr:4 row_mask:0xf bank_mask:0xf
    v_add_f32_dpp v18, v18, v18 row_shr:4 row_mask:0xf bank_mask:0xf
    v_add_f32_dpp v20, v20, v20 row_shr:4 row_mask:0xf bank_mask:0xf
    v_add_f32_dpp v22, v22, v22 row_shr:4 row_mask:0xf bank_mask:0xf
    v_add_f32_dpp v16, v16, v16 row_shr:8 row_mask:0xf bank_mask:0xf
    v_add_f32_dpp v18, v18, v18 row_shr:8 row_mask:0xf bank_mask:0xf
    v_add_f32_dpp v20, v20, v20 row_shr:8 row_mask:0xf bank_mask:0xf
    v_add_f32_dpp v22, v22, v22 row_shr:8 row_mask:0xf bank_mask:0xf
    v_add_f32_dpp v16, v16, v16 row_bcast:15 row_mask:0xa bank_mask:0xf
    v_add_f32_dpp v18, v18, v18 row_bcast:15 row_mask:0xa bank_mask:0xf
    v_add_f32_dpp v20, v20, v20 row_bcast:15 row_mask:0xa bank_mask:0xf
    v_add_f32_dpp v22, v22, v22 row_bcast:15 row_mask:0xa bank_mask:0xf
    v_add_f32_dpp v16, v16, v16 row_bcast:31 row_mask:0xc bank_mask:0xf
    v_add_f32_dpp v18, v18, v18 row_bcast:31 row_mask:0xc bank_mask:0xf
    v_add_f32_dpp v20, v20, v20 row_bcast:31 row_mask:0xc bank_mask:0xf
    v_add_f32_dpp v22, v22, v22 row_bcast:31 row_mask:0xc bank_mask:0xf
    v_readlane_b32 s60, v16, 63
    v_readlane_b32 s61, v18, 63
    v_readlane_b32 s62, v20, 63
    v_readlane_b32 s63, v22, 63
    v_mov_b32 v16, s60
    v_mov_b32 v18, s61
    v_mov_b32 v20, s62
    v_mov_b32 v22, s63
    v_mul_f32 v16, 0x3b000000, v16
    v_mul_f32 v18, 0x3b000000, v18
    v_mul_f32 v20, 0x3b000000, v20
    v_mul_f32 v22, 0x3b000000, v22
    v_fma_f32 v18, -v16, v16, v18
    v_fma_f32 v22, -v20, v20, v22
    v_max_f32 v18, 0, v18
    v_max_f32 v22, 0, v22
    v_add_f32 v18, 0x3727c5ac, v18
    v_add_f32 v22, 0x3727c5ac, v22
    v_rsq_f32 v18, v18
    v_rsq_f32 v22, v22
    v_mul_f32 v16, v16, v18
    v_mul_f32 v20, v20, v22
    v_pk_fma_f32 v[48:49], v[48:49], v[18:19], v[16:17] op_sel_hi:[1,0,0] neg_lo:[0,0,1] neg_hi:[0,0,1]
    v_pk_fma_f32 v[50:51], v[50:51], v[18:19], v[16:17] op_sel_hi:[1,0,0] neg_lo:[0,0,1] neg_hi:[0,0,1]
    v_pk_fma_f32 v[52:53], v[52:53], v[18:19], v[16:17] op_sel_hi:[1,0,0] neg_lo:[0,0,1] neg_hi:[0,0,1]
    v_pk_fma_f32 v[54:55], v[54:55], v[18:19], v[16:17] op_sel_hi:[1,0,0] neg_lo:[0,0,1] neg_hi:[0,0,1]
    v_pk_fma_f32 v[56:57], v[56:57], v[22:23], v[20:21] op_sel_hi:[1,0,0] neg_lo:[0,0,1] neg_hi:[0,0,1]
    v_pk_fma_f32 v[58:59], v[58:59], v[22:23], v[20:21] op_sel_hi:[1,0,0] neg_lo:[0,0,1] neg_hi:[0,0,1]
    v_pk_fma_f32 v[60:61], v[60:61], v[22:23], v[20:21] op_sel_hi:[1,0,0] neg_lo:[0,0,1] neg_hi:[0,0,1]
    v_pk_fma_f32 v[62:63], v[62:63], v[22:23], v[20:21] op_sel_hi:[1,0,0] neg_lo:[0,0,1] neg_hi:[0,0,1]
    v_cvt_pk_bf16_f32 v24, v48, v49
    v_cvt_pk_bf16_f32 v28, v56, v57
    v_cvt_pk_bf16_f32 v25, v50, v51
    v_cvt_pk_bf16_f32 v29, v58, v59
    v_cvt_pk_bf16_f32 v26, v52, v53
    v_cvt_pk_bf16_f32 v30, v60, v61
    v_cvt_pk_bf16_f32 v27, v54, v55
    v_cvt_pk_bf16_f32 v31, v62, v63
    s_lshl_b32 s56, s33, 1
    s_mul_i32 s56, s56, 1088
    s_add_u32 s56, s56, 114688
    v_add_u32 v16, s56, v2
    ds_write_b128 v16, v[24:27]
    ds_write_b128 v16, v[28:31] offset:1088
    v_and_b32 v16, 7, v1
    v_lshrrev_b32 v17, 3, v1
    v_mul_u32_u24 v18, 1088, v16
    v_lshlrev_b32 v19, 4, v17
    v_add_u32 v18, v18, v19
    s_lshl_b32 s56, s33, 8
    s_add_u32 s56, s56, 114688
    v_add_u32 v18, s56, v18
    v_lshlrev_b32 v16, 4, v16
    v_lshlrev_b32 v17, 9, v17
    v_add_u32 v16, v16, v17
    s_lshr_b32 s56, s32, 5
    s_lshl_b32 s56, s56, 15
    s_and_b32 s57, s32, 31
    s_lshl_b32 s57, s57, 4
    s_add_u32 s56, s56, s57
    s_lshl_b32 s57, s33, 13
    s_add_u32 s56, s56, s57
    s_add_u32 s57, s56, 4096
    s_waitcnt lgkmcnt(0)
    s_barrier
    ds_read_b128 v[24:27], v18
    ds_read_b128 v[28:31], v18 offset:128
    s_waitcnt lgkmcnt(0)
    buffer_store_dwordx4 v[24:27], v16, s[48:51], s56 offen
    buffer_store_dwordx4 v[28:31], v16, s[48:51], s57 offen
    s_mov_b32 s72, 5
    s_mov_b32 s73, 6
    s_mov_b32 s74, 7
    s_mov_b32 s75, 3
    s_mov_b32 s76, 4
    s_mov_b32 s77, 0
    s_mov_b32 s78, 1
    s_mov_b32 s79, 2
    s_mov_b32 s70, 1
    s_branch chain_pass
chain_done2:
mega_done:
    s_endpgm
mega_end:
.section .rodata,"a"
.p2align 6
.amdhsa_kernel interleave_layers__ssm_conv_h3__glu_gated_geglu__prompt_kernel
  .amdhsa_next_free_vgpr 512
  .amdhsa_next_free_sgpr 102
  .amdhsa_accum_offset 256
  .amdhsa_group_segment_fixed_size 0
  .amdhsa_kernarg_size 104
  .amdhsa_user_sgpr_count 2
  .amdhsa_user_sgpr_kernarg_segment_ptr 1
  .amdhsa_system_sgpr_workgroup_id_x 1
  .amdhsa_float_denorm_mode_32 3
  .amdhsa_float_denorm_mode_16_64 3
.end_amdhsa_kernel
.text
```
